```python
import torch

def _softmax(x, axis=-1):
    return torch.softmax(x, dim=axis)
def _gelu(x):
    return torch.nn.functional.gelu(x, approximate="tanh")
def _silu(x):
    return torch.nn.functional.silu(x)
def _sigmoid(x):
    return torch.sigmoid(x)
def _layernorm(x, axis=-1, eps=1e-5):
    m = x.mean(dim=axis, keepdim=True)
    v = x.var(dim=axis, keepdim=True, unbiased=False)
    return (x - m) / torch.sqrt(v + eps)
def _scatter_add(tgt, idx, src, axis=0):
    return tgt.clone().index_add_(axis, idx, src)
def _segment_sum(src, seg, n):
    out = torch.zeros((n,) + src.shape[1:], dtype=src.dtype)
    return out.index_add_(0, seg, src)
def _pad(x, pw):
    flat = tuple(v for pair in reversed(pw) for v in pair)
    return torch.nn.functional.pad(x, flat)

kernel_name = 'parallel_sum__gqa_block_cached__glu_gated_bilinear__decode'

def setup_inputs():

    _w = (lambda a: (lambda t: t.to(torch.bfloat16) if t.is_floating_point() else t)(torch.as_tensor(a)))
    def _A_setup():
        B, Sq, D = 2, 1, 576
        Hq, Hkv, Sk, Dh = 32, 16, 4096, 128
        assert Hq % Hkv == 0, (Hq, Hkv)
        return {
            "x": _w((lambda *s: torch.randn(*s, dtype=torch.bfloat16) * 0.05)(B, Sq, D)),
            "k_cache": _w((lambda *s: torch.randn(*s, dtype=torch.bfloat16) * 1.6)(B, Hkv, Sk, Dh)),
            "v_cache": _w((lambda *s: torch.randn(*s, dtype=torch.bfloat16) * 0.8)(B, Hkv, Sk, Dh)),
            "wq": _w((lambda *s: torch.randn(*s, dtype=torch.bfloat16) * 1.6)(D, Hq * Dh) * (D ** -0.5)),
            "wo": _w((lambda *s: torch.randn(*s, dtype=torch.bfloat16) * 0.8)(Hq * Dh, D) * ((Hq * Dh) ** -0.5)),
        }
    _A_in = _A_setup()

    def _B_setup():
        B, S, D, F = 2, 1, 576, 4608
        return {
            "x": _w((lambda *s: torch.randn(*s, dtype=torch.bfloat16) * 0.05)(B, S, D)),
            "w_gate": _w((lambda *s: torch.randn(*s, dtype=torch.bfloat16) * 0.4)(D, F) * (D ** -0.5)),
            "w_up": _w((lambda *s: torch.randn(*s, dtype=torch.bfloat16) * 0.4)(D, F) * (D ** -0.5)),
            "w_down": _w((lambda *s: torch.randn(*s, dtype=torch.bfloat16) * 0.4)(F, D) * (F ** -0.5)),
        }
    _B_in = _B_setup()

    return {
        "A_x": _A_in["x"],
        "A_k_cache": _A_in["k_cache"],
        "A_v_cache": _A_in["v_cache"],
        "A_wq": _A_in["wq"],
        "A_wo": _A_in["wo"],
        "B_x": _B_in["x"],
        "B_w_gate": _B_in["w_gate"],
        "B_w_up": _B_in["w_up"],
        "B_w_down": _B_in["w_down"],
    }

def reference(A_x, A_k_cache, A_v_cache, A_wq, A_wo, B_x, B_w_gate, B_w_up, B_w_down):
    def _A_ref(x, k_cache, v_cache, wq, wo):
        B, Sq, D = x.shape
        Hq, Dh = 32, 128
        Hkv = k_cache.shape[1]
        rep = Hq // Hkv
        q = (lambda x, *d: x.permute(*d))((x @ wq).reshape(B, Sq, Hq, Dh), 0, 2, 1, 3)
        k = (lambda x, n, axis: torch.repeat_interleave(x, n, dim=axis))(k_cache, rep, axis=1)
        v = (lambda x, n, axis: torch.repeat_interleave(x, n, dim=axis))(v_cache, rep, axis=1)
        scores = torch.einsum("bhqd,bhkd->bhqk", q, k) * (Dh ** -0.5)
        p = _softmax(scores, axis=-1)
        o = torch.einsum("bhqk,bhkd->bhqd", p, v)
        return (lambda x, *d: x.permute(*d))(o, 0, 2, 1, 3).reshape(B, Sq, Hq * Dh) @ wo

    def _B_ref(x, w_gate, w_up, w_down):
        g = torch.einsum("bsd,df->bsf", x, w_gate)
        u = torch.einsum("bsd,df->bsf", x, w_up)
        h = g * u
        return torch.einsum("bsf,fd->bsd", h, w_down)

    x = A_x
    xn = _layernorm(x, axis=-1)
    return x + _A_ref(xn, A_k_cache, A_v_cache, A_wq, A_wo) + _B_ref(xn, B_w_gate, B_w_up, B_w_down)
```

```asm
; @launch grid=(256,1,1) block=(1024,1,1) lds=32768
.amdgcn_target "amdgcn-amd-amdhsa--gfx950"
.text
.globl parallel_sum__gqa_block_cached__glu_gated_bilinear__decode_kernel
.p2align 8
.type parallel_sum__gqa_block_cached__glu_gated_bilinear__decode_kernel,@function
parallel_sum__gqa_block_cached__glu_gated_bilinear__decode_kernel:
    s_cmp_ge_u32 s2, 256
    s_cbranch_scc1 L_end
    s_load_dwordx16 s[4:19], s[0:1], 0
    s_load_dwordx8 s[20:27], s[0:1], 64
    v_lshrrev_b32 v4, 6, v0
    v_and_b32 v1, 63, v0
    v_readfirstlane_b32 s30, v4
    s_lshr_b32 s40, s2, 7
    s_bfe_u32 s38, s2, 0x40003
    s_and_b32 s41, s2, 7
    s_lshl_b32 s39, s40, 3
    s_or_b32 s39, s39, s41
    s_lshr_b32 s3, s2, 3
    s_lshl_b32 s3, s3, 20
    s_mov_b32 s36, 0x05040100
    s_mov_b32 s37, 0x07060302
    s_mov_b32 s42, 0x200000
    v_mov_b32 v2, 0
    v_mov_b32 v3, 1
    v_mov_b32 v19, 0xfff
    s_and_b32 s31, s30, 7
    v_and_b32 v16, 15, v1
    v_lshrrev_b32 v17, 4, v1
    s_cmp_ge_u32 s30, 8
    s_cbranch_scc1 L_vwave
    v_bfe_u32 v4, v1, 2, 2
    v_lshlrev_b32 v5, 8, v4
    v_lshl_or_b32 v5, v17, 6, v5
    v_and_b32 v4, 3, v1
    v_lshl_or_b32 v5, v4, 4, v5
    s_lshl_b32 s64, s41, 3
    s_lshl_b32 s61, s31, 1
    s_add_u32 s64, s64, s61
    s_waitcnt lgkmcnt(0)
    s_load_dwordx2 s[28:29], s[26:27], 0
    s_cmp_ge_u32 s31, 4
    s_cbranch_scc1 L_kdb
    s_setprio 2
    s_lshl_b32 s60, s64, 13
    s_add_u32 s60, s60, s3
    s_add_u32 s44, s6, s60
    s_addc_u32 s45, s7, 0
    global_load_dwordx4 v[64:67], v5, s[44:45] offset:0 nt
    global_load_dwordx4 v[68:71], v5, s[44:45] offset:1024 nt
    global_load_dwordx4 v[72:75], v5, s[44:45] offset:2048 nt
    global_load_dwordx4 v[76:79], v5, s[44:45] offset:3072 nt
    s_add_u32 s44, s44, 4096
    s_addc_u32 s45, s45, 0
    global_load_dwordx4 v[80:83], v5, s[44:45] offset:0 nt
    global_load_dwordx4 v[84:87], v5, s[44:45] offset:1024 nt
    global_load_dwordx4 v[88:91], v5, s[44:45] offset:2048 nt
    global_load_dwordx4 v[92:95], v5, s[44:45] offset:3072 nt
    s_barrier
    s_add_u32 s64, s64, 1
    s_lshl_b32 s60, s64, 13
    s_add_u32 s60, s60, s3
    s_add_u32 s44, s6, s60
    s_addc_u32 s45, s7, 0
    global_load_dwordx4 v[96:99], v5, s[44:45] offset:0 nt
    global_load_dwordx4 v[100:103], v5, s[44:45] offset:1024 nt
    global_load_dwordx4 v[104:107], v5, s[44:45] offset:2048 nt
    global_load_dwordx4 v[108:111], v5, s[44:45] offset:3072 nt
    s_add_u32 s44, s44, 4096
    s_addc_u32 s45, s45, 0
    global_load_dwordx4 v[112:115], v5, s[44:45] offset:0 nt
    global_load_dwordx4 v[116:119], v5, s[44:45] offset:1024 nt
    global_load_dwordx4 v[120:123], v5, s[44:45] offset:2048 nt
    global_load_dwordx4 v[124:127], v5, s[44:45] offset:3072 nt
    s_waitcnt lgkmcnt(0)
    s_mov_b64 exec, 1
    ds_add_u32 v2, v3 offset:8
    s_mov_b64 exec, -1
    s_branch L_k2
L_kdb:
    s_barrier
    s_branch L_kdyn00
L_vwave:
    s_setprio 3
    s_cmp_ge_u32 s31, 6
    s_cbranch_scc1 L_v67
    s_lshr_b32 s60, s39, 1
    s_mul_i32 s60, s60, 72
    s_mul_i32 s61, s31, 12
    s_add_u32 s64, s60, s61
    s_lshl_b32 s60, s64, 13
    s_lshl_b32 s61, s38, 9
    s_add_u32 s60, s60, s61
    s_and_b32 s61, s39, 1
    s_lshl_b32 s61, s61, 8
    s_add_u32 s60, s60, s61
    v_lshlrev_b32 v4, 13, v17
    v_lshl_add_u32 v4, v16, 4, v4
    s_waitcnt lgkmcnt(0)
    s_load_dwordx2 s[28:29], s[26:27], 0
    s_add_u32 s44, s10, s60
    s_addc_u32 s45, s11, 0
    global_load_dwordx4 v[64:67], v4, s[44:45] nt
    s_add_u32 s44, s44, 32768
    s_addc_u32 s45, s45, 0
    global_load_dwordx4 v[68:71], v4, s[44:45] nt
    s_add_u32 s44, s44, 32768
    s_addc_u32 s45, s45, 0
    global_load_dwordx4 v[72:75], v4, s[44:45] nt
    s_barrier
    v_and_b32 v4, 1, v1
    v_mul_u32_u24 v4, 1152, v4
    v_lshl_add_u32 v4, v17, 1, v4
    s_lshl_b32 s60, s64, 1
    v_add_u32 v4, s60, v4
    s_waitcnt lgkmcnt(0)
    s_add_u32 s28, s28, 1
    s_and_b32 s32, s28, 0xfff
    s_bfe_u32 s33, s28, 0xc000c
    s_lshr_b64 s[60:61], s[28:29], 24
    s_and_b32 s34, s60, 0xfff
    s_lshr_b64 s[60:61], s[28:29], 36
    s_and_b32 s35, s60, 0xfff
L_spin_35:
    ds_read_b32 v5, v2 offset:0
    s_waitcnt lgkmcnt(0)
    v_readfirstlane_b32 s60, v5
    s_nop 0
    s_cmp_ge_u32 s60, 2
    s_cbranch_scc1 L_spind_36
    s_sub_u32 s42, s42, 1
    s_cbranch_scc1 L_spind_36
    s_branch L_spin_35
L_spind_36:
    ds_read_u16 v8, v4 offset:512
    ds_read_u16 v10, v4 offset:520
    ds_read_u16 v9, v4 offset:528
    s_waitcnt lgkmcnt(0)
    v_lshl_or_b32 v8, v10, 16, v8
    s_waitcnt vmcnt(0)
    v_perm_b32 v10, v68, v64, s36
    v_and_b32 v11, 0xffff, v72
    v_perm_b32 v12, v68, v64, s37
    v_lshrrev_b32 v13, 16, v72
    v_mfma_f32_16x16x16_bf16 v[32:35], v[8:9], v[10:11], 0
    v_perm_b32 v10, v69, v65, s36
    v_and_b32 v11, 0xffff, v73
    v_mfma_f32_16x16x16_bf16 v[36:39], v[8:9], v[12:13], 0
    v_perm_b32 v12, v69, v65, s37
    v_lshrrev_b32 v13, 16, v73
    v_mfma_f32_16x16x16_bf16 v[40:43], v[8:9], v[10:11], 0
    v_perm_b32 v10, v70, v66, s36
    v_and_b32 v11, 0xffff, v74
    v_mfma_f32_16x16x16_bf16 v[44:47], v[8:9], v[12:13], 0
    v_perm_b32 v12, v70, v66, s37
    v_lshrrev_b32 v13, 16, v74
    v_mfma_f32_16x16x16_bf16 v[48:51], v[8:9], v[10:11], 0
    v_perm_b32 v10, v71, v67, s36
    v_and_b32 v11, 0xffff, v75
    v_mfma_f32_16x16x16_bf16 v[52:55], v[8:9], v[12:13], 0
    v_perm_b32 v12, v71, v67, s37
    v_lshrrev_b32 v13, 16, v75
    v_mfma_f32_16x16x16_bf16 v[56:59], v[8:9], v[10:11], 0
    s_nop 0
    v_mfma_f32_16x16x16_bf16 v[60:63], v[8:9], v[12:13], 0
    v_mov_b32 v64, v32
    v_mov_b32 v65, v36
    v_mov_b32 v66, v40
    v_mov_b32 v67, v44
    v_mov_b32 v68, v48
    v_mov_b32 v69, v52
    v_mov_b32 v70, v56
    s_nop 0
    v_mov_b32 v71, v60
    v_mov_b32 v72, v33
    v_mov_b32 v73, v37
    v_mov_b32 v74, v41
    v_mov_b32 v75, v45
    v_mov_b32 v76, v49
    v_mov_b32 v77, v53
    v_mov_b32 v78, v57
    v_mov_b32 v79, v61
    v_lshlrev_b32 v4, 5, v16
    s_lshl_b32 s60, s31, 10
    v_add_u32 v4, s60, v4
    s_mov_b64 exec, 0xffff
    ds_write_b128 v4, v[64:67] offset:8192
    ds_write_b128 v4, v[68:71] offset:8208
    ds_write_b128 v4, v[72:75] offset:8704
    ds_write_b128 v4, v[76:79] offset:8720
    s_mov_b64 exec, -1
    s_waitcnt lgkmcnt(0)
    s_mov_b64 exec, 1
    ds_add_rtn_u32 v4, v2, v3 offset:4
    s_mov_b64 exec, -1
    s_waitcnt lgkmcnt(0)
    v_readfirstlane_b32 s60, v4
    s_nop 0
    s_cmp_lg_u32 s60, 5
    s_cbranch_scc1 L_vgu0
    v_lshlrev_b32 v4, 4, v1
    ds_read_b128 v[64:67], v4 offset:8192
    ds_read_b128 v[68:71], v4 offset:9216
    ds_read_b128 v[72:75], v4 offset:10240
    ds_read_b128 v[76:79], v4 offset:11264
    ds_read_b128 v[80:83], v4 offset:12288
    ds_read_b128 v[84:87], v4 offset:13312
    v_lshrrev_b32 v5, 5, v1
    v_lshlrev_b32 v5, 13, v5
    v_and_b32 v6, 31, v1
    v_lshl_add_u32 v5, v6, 4, v5
    s_lshl_b32 s60, s38, 14
    s_lshr_b32 s61, s39, 1
    s_lshl_b32 s61, s61, 10
    s_add_u32 s60, s60, s61
    s_and_b32 s61, s39, 1
    s_lshl_b32 s61, s61, 9
    s_add_u32 s60, s60, s61
    s_add_u32 s60, s60, 65536
    s_add_u32 s44, s26, s60
    s_addc_u32 s45, s27, 0
    s_waitcnt lgkmcnt(0)
    v_add_f32 v64, v64, v68
    v_add_f32 v65, v65, v69
    v_add_f32 v66, v66, v70
    v_add_f32 v67, v67, v71
    v_add_f32 v64, v64, v72
    v_add_f32 v65, v65, v73
    v_add_f32 v66, v66, v74
    v_add_f32 v67, v67, v75
    v_add_f32 v64, v64, v76
    v_add_f32 v65, v65, v77
    v_add_f32 v66, v66, v78
    v_add_f32 v67, v67, v79
    v_add_f32 v64, v64, v80
    v_add_f32 v65, v65, v81
    v_add_f32 v66, v66, v82
    v_add_f32 v67, v67, v83
    v_add_f32 v64, v64, v84
    v_add_f32 v65, v65, v85
    v_add_f32 v66, v66, v86
    v_add_f32 v67, v67, v87
    v_bfi_b32 v64, v19, s32, v64
    v_bfi_b32 v65, v19, s33, v65
    v_bfi_b32 v66, v19, s34, v66
    v_bfi_b32 v67, v19, s35, v67
    global_store_dwordx4 v5, v[64:67], s[44:45] sc1
    s_branch L_vgu0
L_v67:
    s_sub_u32 s64, s31, 6
    s_mul_i32 s64, s64, 1152
    v_lshlrev_b32 v4, 2, v1
    v_add_u32 v5, s64, v4
    v_mov_b32 v64, 0
    v_mov_b32 v65, 0
    v_mov_b32 v66, 0
    v_mov_b32 v67, 0
    v_mov_b32 v68, 0
    v_mov_b32 v69, 0
    v_mov_b32 v70, 0
    v_mov_b32 v71, 0
    v_mov_b32 v72, 0
    v_mov_b32 v73, 0
    s_waitcnt lgkmcnt(0)
    s_load_dwordx2 s[28:29], s[26:27], 0
    global_load_dword v64, v5, s[4:5] offset:0
    global_load_dword v65, v5, s[4:5] offset:256
    global_load_dword v66, v5, s[4:5] offset:512
    global_load_dword v67, v5, s[4:5] offset:768
    s_mov_b32 exec_hi, 0
    global_load_dword v68, v5, s[4:5] offset:1024
    s_mov_b64 exec, -1
    s_cmp_lg_u32 s31, 6
    s_cbranch_scc1 L_noz_37
    ds_write_b32 v4, v2
    ds_write_b32 v4, v2 offset:256
    ds_write_b32 v4, v2 offset:5696
    ds_write_b32 v4, v2 offset:6144
    v_mov_b32 v8, 0xff000000
    v_mov_b32 v9, 0
    v_lshlrev_b32 v10, 3, v1
    s_mov_b64 exec, 0xffff
    ds_write_b64 v10, v[8:9] offset:5504
    s_mov_b64 exec, -1
    s_waitcnt lgkmcnt(0)
L_noz_37:
    s_barrier
    s_waitcnt lgkmcnt(0)
    s_add_u32 s28, s28, 1
    s_and_b32 s32, s28, 0xfff
    s_bfe_u32 s33, s28, 0xc000c
    s_lshr_b64 s[60:61], s[28:29], 24
    s_and_b32 s34, s60, 0xfff
    s_lshr_b64 s[60:61], s[28:29], 36
    s_and_b32 s35, s60, 0xfff
    s_cmp_lg_u32 s31, 6
    s_cbranch_scc1 L_noc_38
    s_cmp_lg_u32 s41, 0
    s_cbranch_scc1 L_noc_38
    s_lshl_b32 s60, s29, 16
    v_mov_b32 v8, s60
    v_mov_b32 v9, s28
    s_lshr_b32 s60, s2, 3
    s_lshl_b32 s60, s60, 8
    s_add_u32 s60, s60, 8192
    v_mov_b32 v10, s60
    s_mov_b64 exec, 1
    global_store_dwordx2 v10, v[8:9], s[26:27] sc1
    s_mov_b64 exec, -1
L_noc_38:
    s_waitcnt vmcnt(1)
    s_cmp_lg_u32 s31, 6
    s_cselect_b32 s60, 1, 0
    s_cmp_lg_u32 s41, 0
    s_cselect_b32 s60, 1, s60
    s_cmp_eq_u32 s60, 0
    s_cbranch_scc1 L_xw_39
    s_waitcnt vmcnt(0)
L_xw_39:
    v_lshlrev_b32 v80, 16, v64
    v_and_b32 v81, 0xffff0000, v64
    v_lshlrev_b32 v82, 16, v65
    v_and_b32 v83, 0xffff0000, v65
    v_lshlrev_b32 v84, 16, v66
    v_and_b32 v85, 0xffff0000, v66
    v_lshlrev_b32 v86, 16, v67
    v_and_b32 v87, 0xffff0000, v67
    v_lshlrev_b32 v88, 16, v68
    v_and_b32 v89, 0xffff0000, v68
    v_add_f32 v34, v80, v81
    v_add_f32 v35, v82, v83
    v_add_f32 v36, v84, v85
    v_add_f32 v37, v86, v87
    v_add_f32 v38, v88, v89
    v_add_f32 v34, v34, v35
    v_add_f32 v36, v36, v37
    v_add_f32 v34, v34, v38
    v_add_f32 v8, v34, v36
    s_nop 1
    v_add_f32_dpp v8, v8, v8 quad_perm:[1,0,3,2] row_mask:0xf bank_mask:0xf
    s_nop 1
    v_add_f32_dpp v8, v8, v8 quad_perm:[2,3,0,1] row_mask:0xf bank_mask:0xf
    s_nop 1
    v_add_f32_dpp v8, v8, v8 row_ror:4 row_mask:0xf bank_mask:0xf
    s_nop 1
    v_add_f32_dpp v8, v8, v8 row_ror:8 row_mask:0xf bank_mask:0xf
    v_mov_b32 v33, v8
    s_nop 1
    v_permlane16_swap_b32 v8, v33
    v_add_f32 v8, v8, v33
    v_mov_b32 v33, v8
    s_nop 1
    v_permlane32_swap_b32 v8, v33
    v_add_f32 v8, v8, v33
    s_mov_b32 s60, 0x3ae38e39
    v_mul_f32 v8, s60, v8
    v_sub_f32 v100, v80, v8
    v_sub_f32 v101, v81, v8
    v_sub_f32 v102, v82, v8
    v_sub_f32 v103, v83, v8
    v_sub_f32 v104, v84, v8
    v_sub_f32 v105, v85, v8
    v_sub_f32 v106, v86, v8
    v_sub_f32 v107, v87, v8
    v_mov_b32 v108, 0
    v_mov_b32 v109, 0
    s_mov_b32 exec_hi, 0
    v_sub_f32 v108, v88, v8
    v_sub_f32 v109, v89, v8
    s_mov_b64 exec, -1
    v_mul_f32 v34, v100, v100
    v_mul_f32 v35, v102, v102
    v_mul_f32 v36, v104, v104
    v_mul_f32 v37, v106, v106
    v_mul_f32 v38, v108, v108
    v_fmac_f32 v34, v101, v101
    v_fmac_f32 v35, v103, v103
    v_fmac_f32 v36, v105, v105
    v_fmac_f32 v37, v107, v107
    v_fmac_f32 v38, v109, v109
    v_add_f32 v34, v34, v35
    v_add_f32 v36, v36, v37
    v_add_f32 v34, v34, v38
    v_add_f32 v9, v34, v36
    s_nop 1
    v_add_f32_dpp v9, v9, v9 quad_perm:[1,0,3,2] row_mask:0xf bank_mask:0xf
    s_nop 1
    v_add_f32_dpp v9, v9, v9 quad_perm:[2,3,0,1] row_mask:0xf bank_mask:0xf
    s_nop 1
    v_add_f32_dpp v9, v9, v9 row_ror:4 row_mask:0xf bank_mask:0xf
    s_nop 1
    v_add_f32_dpp v9, v9, v9 row_ror:8 row_mask:0xf bank_mask:0xf
    v_mov_b32 v33, v9
    s_nop 1
    v_permlane16_swap_b32 v9, v33
    v_add_f32 v9, v9, v33
    v_mov_b32 v33, v9
    s_nop 1
    v_permlane32_swap_b32 v9, v33
    v_add_f32 v9, v9, v33
    v_mul_f32 v9, s60, v9
    v_cvt_pk_bf16_f32 v8, v8, v8
    v_and_b32 v8, 0xffff0000, v8
    v_cvt_pk_bf16_f32 v9, v9, v9
    v_and_b32 v9, 0xffff0000, v9
    v_add_f32 v9, 0x3727c5ac, v9
    v_cvt_pk_bf16_f32 v9, v9, v9
    v_and_b32 v9, 0xffff0000, v9
    v_sqrt_f32 v9, v9
    s_nop 0
    v_cvt_pk_bf16_f32 v9, v9, v9
    v_and_b32 v9, 0xffff0000, v9
    v_rcp_f32 v10, v9
    s_nop 0
    v_fma_f32 v11, -v9, v10, 1.0
    v_fma_f32 v10, v10, v11, v10
    v_sub_f32 v100, v80, v8
    v_sub_f32 v101, v81, v8
    v_sub_f32 v102, v82, v8
    v_sub_f32 v103, v83, v8
    v_sub_f32 v104, v84, v8
    v_sub_f32 v105, v85, v8
    v_sub_f32 v106, v86, v8
    v_sub_f32 v107, v87, v8
    v_sub_f32 v108, v88, v8
    v_sub_f32 v109, v89, v8
    v_cvt_pk_bf16_f32 v34, v100, v101
    v_cvt_pk_bf16_f32 v35, v102, v103
    v_cvt_pk_bf16_f32 v36, v104, v105
    v_cvt_pk_bf16_f32 v37, v106, v107
    v_cvt_pk_bf16_f32 v38, v108, v109
    v_lshlrev_b32 v100, 16, v34
    v_and_b32 v101, 0xffff0000, v34
    v_lshlrev_b32 v102, 16, v35
    v_and_b32 v103, 0xffff0000, v35
    v_lshlrev_b32 v104, 16, v36
    v_and_b32 v105, 0xffff0000, v36
    v_lshlrev_b32 v106, 16, v37
    v_and_b32 v107, 0xffff0000, v37
    v_lshlrev_b32 v108, 16, v38
    v_and_b32 v109, 0xffff0000, v38
    v_mul_f32 v100, v100, v10
    v_mul_f32 v101, v101, v10
    v_mul_f32 v102, v102, v10
    v_mul_f32 v103, v103, v10
    v_mul_f32 v104, v104, v10
    v_mul_f32 v105, v105, v10
    v_mul_f32 v106, v106, v10
    v_mul_f32 v107, v107, v10
    v_mul_f32 v108, v108, v10
    v_mul_f32 v109, v109, v10
    v_cvt_pk_bf16_f32 v34, v100, v101
    v_cvt_pk_bf16_f32 v35, v102, v103
    v_cvt_pk_bf16_f32 v36, v104, v105
    v_cvt_pk_bf16_f32 v37, v106, v107
    v_cvt_pk_bf16_f32 v38, v108, v109
    ds_write_b32 v5, v34 offset:512
    ds_write_b32 v5, v35 offset:768
    ds_write_b32 v5, v36 offset:1024
    ds_write_b32 v5, v37 offset:1280
    s_mov_b32 exec_hi, 0
    ds_write_b32 v5, v38 offset:1536
    s_mov_b64 exec, -1
    s_waitcnt lgkmcnt(0)
    s_mov_b64 exec, 1
    ds_add_u32 v2, v3 offset:0
    s_mov_b64 exec, -1
    s_branch L_vgu0
L_k2:
    s_setprio 2
    s_waitcnt lgkmcnt(0)
    s_add_u32 s28, s28, 1
    s_and_b32 s32, s28, 0xfff
    s_bfe_u32 s33, s28, 0xc000c
    s_lshr_b64 s[60:61], s[28:29], 24
    s_and_b32 s34, s60, 0xfff
    s_lshr_b64 s[60:61], s[28:29], 36
    s_and_b32 s35, s60, 0xfff
    v_lshrrev_b32 v6, 3, v1
    v_lshlrev_b32 v6, 10, v6
    v_and_b32 v7, 7, v1
    v_lshl_or_b32 v6, v7, 4, v6
    s_lshl_b32 s62, s31, 8
    v_add_u32 v6, s62, v6
    s_lshl_b32 s60, s38, 1
    s_add_u32 s60, s60, s40
    s_lshl_b32 s60, s60, 13
    s_add_u32 s60, s60, 65536
    s_add_u32 s46, s26, s60
    s_addc_u32 s47, s27, 0
L_spin_1:
    ds_read_b32 v8, v2 offset:12
    s_waitcnt lgkmcnt(0)
    v_readfirstlane_b32 s60, v8
    s_nop 0
    s_cmp_ge_u32 s60, 8
    s_cbranch_scc1 L_spind_2
    s_sub_u32 s42, s42, 1
    s_cbranch_scc1 L_spind_2
    s_sleep 1
    s_branch L_spin_1
L_spind_2:
    s_setprio 3
L_qpoll_3:
    global_load_dwordx4 v[20:23], v6, s[46:47] sc1
    global_load_dwordx4 v[24:27], v6, s[46:47] offset:128 sc1
    s_waitcnt vmcnt(0)
    v_xor_b32 v8, s32, v20
    v_xor_b32 v9, s33, v21
    v_xor_b32 v10, s34, v22
    v_or3_b32 v8, v8, v9, v10
    v_xor_b32 v9, s35, v23
    v_or_b32 v8, v8, v9
    v_and_b32 v8, v19, v8
    v_cmp_ne_u32 vcc, 0, v8
    s_nop 0
    s_mov_b64 s[62:63], vcc
    v_xor_b32 v8, s32, v24
    v_xor_b32 v9, s33, v25
    v_xor_b32 v10, s34, v26
    v_or3_b32 v8, v8, v9, v10
    v_xor_b32 v9, s35, v27
    v_or_b32 v8, v8, v9
    v_and_b32 v8, v19, v8
    v_cmp_ne_u32 vcc, 0, v8
    s_nop 0
    s_or_b64 vcc, vcc, s[62:63]
    s_cbranch_vccz L_qdone_4
    s_sub_u32 s42, s42, 64
    s_cbranch_scc0 L_qpoll_3
L_qdone_4:
    v_and_b32 v20, 0xfffff000, v20
    v_and_b32 v21, 0xfffff000, v21
    v_and_b32 v22, 0xfffff000, v22
    v_and_b32 v23, 0xfffff000, v23
    v_and_b32 v24, 0xfffff000, v24
    v_and_b32 v25, 0xfffff000, v25
    v_and_b32 v26, 0xfffff000, v26
    v_and_b32 v27, 0xfffff000, v27
    v_add_f32_dpp v20, v20, v20 row_ror:8 row_mask:0xf bank_mask:0xf
    v_add_f32_dpp v21, v21, v21 row_ror:8 row_mask:0xf bank_mask:0xf
    v_add_f32_dpp v22, v22, v22 row_ror:8 row_mask:0xf bank_mask:0xf
    v_add_f32_dpp v23, v23, v23 row_ror:8 row_mask:0xf bank_mask:0xf
    v_add_f32_dpp v24, v24, v24 row_ror:8 row_mask:0xf bank_mask:0xf
    v_add_f32_dpp v25, v25, v25 row_ror:8 row_mask:0xf bank_mask:0xf
    v_add_f32_dpp v26, v26, v26 row_ror:8 row_mask:0xf bank_mask:0xf
    v_add_f32_dpp v27, v27, v27 row_ror:8 row_mask:0xf bank_mask:0xf
    v_mov_b32 v32, v20
    v_mov_b32 v33, v21
    v_mov_b32 v34, v22
    v_mov_b32 v35, v23
    v_mov_b32 v36, v24
    v_mov_b32 v37, v25
    v_mov_b32 v38, v26
    v_mov_b32 v39, v27
    v_permlane16_swap_b32 v20, v32
    v_permlane16_swap_b32 v21, v33
    v_permlane16_swap_b32 v22, v34
    v_permlane16_swap_b32 v23, v35
    v_permlane16_swap_b32 v24, v36
    v_permlane16_swap_b32 v25, v37
    v_permlane16_swap_b32 v26, v38
    v_permlane16_swap_b32 v27, v39
    v_add_f32 v20, v20, v32
    v_add_f32 v21, v21, v33
    v_add_f32 v22, v22, v34
    v_add_f32 v23, v23, v35
    v_add_f32 v24, v24, v36
    v_add_f32 v25, v25, v37
    v_add_f32 v26, v26, v38
    v_add_f32 v27, v27, v39
    v_mov_b32 v32, v20
    v_mov_b32 v33, v21
    v_mov_b32 v34, v22
    v_mov_b32 v35, v23
    v_mov_b32 v36, v24
    v_mov_b32 v37, v25
    v_mov_b32 v38, v26
    v_mov_b32 v39, v27
    v_permlane32_swap_b32 v20, v32
    v_permlane32_swap_b32 v21, v33
    v_permlane32_swap_b32 v22, v34
    v_permlane32_swap_b32 v23, v35
    v_permlane32_swap_b32 v24, v36
    v_permlane32_swap_b32 v25, v37
    v_permlane32_swap_b32 v26, v38
    v_permlane32_swap_b32 v27, v39
    v_add_f32 v20, v20, v32
    v_add_f32 v21, v21, v33
    v_add_f32 v22, v22, v34
    v_add_f32 v23, v23, v35
    v_add_f32 v24, v24, v36
    v_add_f32 v25, v25, v37
    v_add_f32 v26, v26, v38
    v_add_f32 v27, v27, v39
    v_cvt_pk_bf16_f32 v8, v20, v21
    v_cvt_pk_bf16_f32 v9, v22, v23
    v_cvt_pk_bf16_f32 v10, v24, v25
    v_cvt_pk_bf16_f32 v11, v26, v27
    v_lshlrev_b32 v12, 3, v7
    s_lshl_b32 s60, s31, 7
    v_add_u32 v12, s60, v12
    s_mov_b64 exec, 0xff
    ds_write_b64 v12, v[8:9] offset:2816
    ds_write_b64 v12, v[10:11] offset:2880
    s_mov_b64 exec, -1
    s_waitcnt lgkmcnt(0)
    s_mov_b64 exec, 1
    ds_add_u32 v2, v3 offset:16
    s_mov_b64 exec, -1
    s_setprio 2
    s_branch L_kq
L_kdyn00:
    s_waitcnt lgkmcnt(0)
    s_add_u32 s28, s28, 1
    s_and_b32 s32, s28, 0xfff
    s_bfe_u32 s33, s28, 0xc000c
    s_lshr_b64 s[60:61], s[28:29], 24
    s_and_b32 s34, s60, 0xfff
    s_lshr_b64 s[60:61], s[28:29], 36
    s_and_b32 s35, s60, 0xfff
    s_lshr_b32 s60, s2, 3
    s_lshl_b32 s60, s60, 8
    s_add_u32 s60, s60, 8192
    s_add_u32 s50, s26, s60
    s_addc_u32 s51, s27, 0
    s_sub_u32 s60, s31, 4
    s_mul_i32 s60, s60, 72
    v_mov_b32 v18, s60
    s_mov_b32 s49, 0
L_spin_5:
    ds_read_b32 v8, v2 offset:12
    s_waitcnt lgkmcnt(0)
    v_readfirstlane_b32 s60, v8
    s_nop 0
    s_cmp_ge_u32 s60, 8
    s_cbranch_scc1 L_spind_6
    s_sub_u32 s42, s42, 1
    s_cbranch_scc1 L_spind_6
    s_sleep 1
    s_branch L_spin_5
L_spind_6:
    s_setprio 2
    s_mov_b32 s66, 1
    s_mov_b32 s67, 0
    s_atomic_add_x2 s[66:67], s[50:51], 0 glc
    s_cmp_ge_u32 s49, 16
    s_cbranch_scc1 L_tke_9
L_tk_7:
    s_waitcnt lgkmcnt(0)
    s_lshr_b32 s68, s66, 16
    s_cmp_eq_u32 s67, s28
    s_cselect_b32 s69, 1, 0
    s_and_b32 s61, s29, 0xffff
    s_cmp_eq_u32 s68, s61
    s_cselect_b32 s68, s69, 0
    s_cmp_lg_u32 s68, 0
    s_cbranch_scc1 L_tko_8
    s_sub_u32 s42, s42, 4096
    s_cbranch_scc1 L_tke_9
    s_mov_b32 s66, 1
    s_mov_b32 s67, 0
    s_atomic_add_x2 s[66:67], s[50:51], 0 glc
    s_branch L_tk_7
L_tko_8:
    s_and_b32 s66, s66, 0xffff
    s_cmp_ge_u32 s66, 64
    s_cbranch_scc1 L_tke_9
    s_add_u32 s64, s66, 64
    s_branch L_tkx_10
L_tke_9:
    s_mov_b32 s64, 65535
L_tkx_10:
    s_add_u32 s49, s49, 1
    v_mov_b32 v12, s64
    s_mov_b64 exec, 1
    ds_write_b32 v18, v12 offset:128
    s_mov_b64 exec, -1
    v_add_u32 v18, 4, v18
    s_setprio 1
    s_cmp_eq_u32 s64, 65535
    s_cbranch_scc1 L_qnt_11
    s_lshl_b32 s60, s64, 13
    s_add_u32 s60, s60, s3
    s_add_u32 s44, s6, s60
    s_addc_u32 s45, s7, 0
    global_load_dwordx4 v[64:67], v5, s[44:45] offset:0 nt
    global_load_dwordx4 v[68:71], v5, s[44:45] offset:1024 nt
    global_load_dwordx4 v[72:75], v5, s[44:45] offset:2048 nt
    global_load_dwordx4 v[76:79], v5, s[44:45] offset:3072 nt
    s_add_u32 s44, s44, 4096
    s_addc_u32 s45, s45, 0
    global_load_dwordx4 v[80:83], v5, s[44:45] offset:0 nt
    global_load_dwordx4 v[84:87], v5, s[44:45] offset:1024 nt
    global_load_dwordx4 v[88:91], v5, s[44:45] offset:2048 nt
    global_load_dwordx4 v[92:95], v5, s[44:45] offset:3072 nt
L_qnt_11:
    s_setprio 2
L_kq:
    s_mov_b32 s52, 0x22222222
    s_mov_b32 s53, 0x22222222
    s_mov_b32 s54, 0x44444444
    s_mov_b32 s55, 0x44444444
    s_mov_b32 s56, 0x88888888
    s_mov_b32 s57, 0x88888888
    s_mov_b32 s58, 0x00ff00ff
    s_mov_b32 s59, 0x00ff00ff
    v_bfe_u32 v8, v16, 2, 1
    v_lshlrev_b32 v8, 8, v8
    v_lshl_or_b32 v8, v17, 6, v8
    v_and_b32 v9, 3, v16
    v_lshl_or_b32 v8, v9, 4, v8
    v_mov_b32 v20, 0xff000000
    v_mov_b32 v21, 0
    s_lshl_b32 s60, s31, 2
    v_mov_b32 v22, s60
    v_lshrrev_b32 v23, 2, v1
    v_lshlrev_b32 v23, 4, v23
    s_lshl_b32 s60, s31, 8
    v_add_u32 v23, s60, v23
    s_mov_b32 s43, 0
L_spin_12:
    ds_read_b32 v10, v2 offset:16
    s_waitcnt lgkmcnt(0)
    v_readfirstlane_b32 s60, v10
    s_nop 0
    s_cmp_ge_u32 s60, 4
    s_cbranch_scc1 L_spind_13
    s_sub_u32 s42, s42, 1
    s_cbranch_scc1 L_spind_13
    s_branch L_spin_12
L_spind_13:
    ds_read_b128 v[12:15], v8 offset:2816
    s_waitcnt lgkmcnt(0)
    v_cndmask_b32 v24, 0, v12, s[58:59]
    v_cndmask_b32 v25, 0, v13, s[58:59]
    v_cndmask_b32 v26, 0, v14, s[58:59]
    v_cndmask_b32 v27, 0, v15, s[58:59]
    v_cndmask_b32 v28, v12, 0, s[58:59]
    v_cndmask_b32 v29, v13, 0, s[58:59]
    v_cndmask_b32 v30, v14, 0, s[58:59]
    v_cndmask_b32 v31, v15, 0, s[58:59]
    s_mov_b32 s65, 1
    s_cmp_ge_u32 s31, 4
    s_cbranch_scc0 L_kstatic
    s_cmp_eq_u32 s64, 65535
    s_cbranch_scc1 L_kfin_dyn
L_kstatic:
L_kloop:
    s_cmp_ge_u32 s31, 4
    s_cbranch_scc0 L_kst_14
    s_waitcnt vmcnt(0)
    s_branch L_kgo_15
L_kst_14:
    s_cmp_lg_u32 s43, 0
    s_cbranch_scc1 L_kw1_16
    s_waitcnt vmcnt(8)
    s_branch L_kgo_15
L_kw1_16:
    s_waitcnt vmcnt(0)
    s_mov_b32 s65, 0
L_kgo_15:
    s_cmp_lt_u32 s43, 2
    s_cbranch_scc1 L_knw_17
    s_sub_u32 s61, s43, 1
L_spin_18:
    ds_read_b32 v12, v22 offset:96
    s_waitcnt lgkmcnt(0)
    v_readfirstlane_b32 s60, v12
    s_nop 0
    s_cmp_ge_u32 s60, s61
    s_cbranch_scc1 L_spind_19
    s_sub_u32 s42, s42, 1
    s_cbranch_scc1 L_spind_19
    s_branch L_spin_18
L_spind_19:
L_knw_17:
    s_cmp_ge_u32 s31, 4
    s_cbranch_scc0 L_kq1_20
    s_cmp_ge_u32 s49, 16
    s_cbranch_scc1 L_tq_22
    s_mov_b32 s66, 1
    s_mov_b32 s67, 0
    s_atomic_add_x2 s[66:67], s[50:51], 0 glc
L_tq_22:
    v_mfma_f32_16x16x32_bf16 v[32:35], v[24:27], v[64:67], 0
    v_mfma_f32_16x16x32_bf16 v[36:39], v[24:27], v[72:75], 0
    v_mfma_f32_16x16x32_bf16 v[40:43], v[24:27], v[80:83], 0
    v_mfma_f32_16x16x32_bf16 v[44:47], v[24:27], v[88:91], 0
    v_mfma_f32_16x16x32_bf16 v[32:35], v[28:31], v[68:71], v[32:35]
    v_mfma_f32_16x16x32_bf16 v[36:39], v[28:31], v[76:79], v[36:39]
    v_mfma_f32_16x16x32_bf16 v[40:43], v[28:31], v[84:87], v[40:43]
    v_mfma_f32_16x16x32_bf16 v[44:47], v[28:31], v[92:95], v[44:47]
    s_nop 4
    v_cndmask_b32 v8, v32, v33, s[52:53]
    v_cndmask_b32 v9, v36, v37, s[52:53]
    v_cndmask_b32 v10, v40, v41, s[52:53]
    v_cndmask_b32 v11, v44, v45, s[52:53]
    v_cndmask_b32 v8, v8, v34, s[54:55]
    v_cndmask_b32 v9, v9, v38, s[54:55]
    v_cndmask_b32 v10, v10, v42, s[54:55]
    v_cndmask_b32 v11, v11, v46, s[54:55]
    v_cndmask_b32 v8, v8, v35, s[56:57]
    v_cndmask_b32 v9, v9, v39, s[56:57]
    v_cndmask_b32 v10, v10, v43, s[56:57]
    v_cndmask_b32 v11, v11, v47, s[56:57]
    v_add_f32_dpp v8, v8, v8 quad_perm:[1,0,3,2] row_mask:0xf bank_mask:0xf
    v_add_f32_dpp v9, v9, v9 quad_perm:[1,0,3,2] row_mask:0xf bank_mask:0xf
    v_add_f32_dpp v10, v10, v10 quad_perm:[1,0,3,2] row_mask:0xf bank_mask:0xf
    v_add_f32_dpp v11, v11, v11 quad_perm:[1,0,3,2] row_mask:0xf bank_mask:0xf
    v_add_f32_dpp v8, v8, v8 quad_perm:[2,3,0,1] row_mask:0xf bank_mask:0xf
    v_add_f32_dpp v9, v9, v9 quad_perm:[2,3,0,1] row_mask:0xf bank_mask:0xf
    v_add_f32_dpp v10, v10, v10 quad_perm:[2,3,0,1] row_mask:0xf bank_mask:0xf
    v_add_f32_dpp v11, v11, v11 quad_perm:[2,3,0,1] row_mask:0xf bank_mask:0xf
    s_mov_b32 s60, 0x3db504f3
    v_cvt_pk_bf16_f32 v48, v8, v9
    v_cvt_pk_bf16_f32 v49, v10, v11
    v_lshlrev_b32 v8, 16, v48
    v_and_b32 v9, 0xffff0000, v48
    v_lshlrev_b32 v10, 16, v49
    v_and_b32 v11, 0xffff0000, v49
    v_mul_f32 v8, s60, v8
    v_mul_f32 v9, s60, v9
    v_mul_f32 v10, s60, v10
    v_mul_f32 v11, s60, v11
    v_cvt_pk_bf16_f32 v48, v8, v9
    v_cvt_pk_bf16_f32 v49, v10, v11
    v_lshlrev_b32 v8, 16, v48
    v_and_b32 v9, 0xffff0000, v48
    v_lshlrev_b32 v10, 16, v49
    v_and_b32 v11, 0xffff0000, v49
    v_max3_f32 v48, v8, v9, v10
    v_max3_f32 v48, v48, v11, v20
    s_nop 1
    v_max_f32_dpp v48, v48, v48 row_ror:4 row_mask:0xf bank_mask:0xf
    s_nop 1
    v_max_f32_dpp v48, v48, v48 row_ror:8 row_mask:0xf bank_mask:0xf
    v_mov_b32 v49, v48
    s_nop 1
    v_permlane32_swap_b32 v48, v49
    v_max_f32 v48, v48, v49
    s_mov_b32 s60, 0x3fb8aa3b
    v_sub_f32 v50, v20, v48
    v_mul_f32 v50, s60, v50
    v_mul_f32 v49, s60, v48
    v_fma_f32 v8, v8, s60, -v49
    v_fma_f32 v9, v9, s60, -v49
    v_fma_f32 v10, v10, s60, -v49
    v_fma_f32 v11, v11, s60, -v49
    v_exp_f32 v50, v50
    v_exp_f32 v8, v8
    v_exp_f32 v9, v9
    v_exp_f32 v10, v10
    v_exp_f32 v11, v11
    v_mov_b32 v20, v48
    v_add_f32 v51, v8, v9
    v_add_f32 v52, v10, v11
    v_add_f32 v51, v51, v52
    s_nop 1
    v_add_f32_dpp v51, v51, v51 row_ror:4 row_mask:0xf bank_mask:0xf
    s_nop 1
    v_add_f32_dpp v51, v51, v51 row_ror:8 row_mask:0xf bank_mask:0xf
    v_mov_b32 v52, v51
    s_nop 1
    v_permlane32_swap_b32 v51, v52
    v_add_f32 v51, v51, v52
    v_fma_f32 v21, v21, v50, v51
    v_mov_b32 v52, v8
    v_mov_b32 v53, v9
    v_mov_b32 v54, v10
    v_mov_b32 v55, v11
    v_permlane32_swap_b32 v8, v52
    v_permlane32_swap_b32 v9, v53
    v_permlane32_swap_b32 v10, v54
    v_permlane32_swap_b32 v11, v55
    v_cvt_pk_bf16_f32 v56, v8, v52
    v_cvt_pk_bf16_f32 v57, v9, v53
    v_cvt_pk_bf16_f32 v58, v10, v54
    v_cvt_pk_bf16_f32 v59, v11, v55
    s_branch L_kq2_21
L_kq1_20:
    s_bitcmp1_b32 s43, 0
    s_cbranch_scc1 L_kq3_23
    v_mfma_f32_16x16x32_bf16 v[32:35], v[24:27], v[64:67], 0
    v_mfma_f32_16x16x32_bf16 v[36:39], v[24:27], v[72:75], 0
    v_mfma_f32_16x16x32_bf16 v[40:43], v[24:27], v[80:83], 0
    v_mfma_f32_16x16x32_bf16 v[44:47], v[24:27], v[88:91], 0
    v_mfma_f32_16x16x32_bf16 v[32:35], v[28:31], v[68:71], v[32:35]
    v_mfma_f32_16x16x32_bf16 v[36:39], v[28:31], v[76:79], v[36:39]
    v_mfma_f32_16x16x32_bf16 v[40:43], v[28:31], v[84:87], v[40:43]
    v_mfma_f32_16x16x32_bf16 v[44:47], v[28:31], v[92:95], v[44:47]
    s_nop 4
    v_cndmask_b32 v8, v32, v33, s[52:53]
    v_cndmask_b32 v9, v36, v37, s[52:53]
    v_cndmask_b32 v10, v40, v41, s[52:53]
    v_cndmask_b32 v11, v44, v45, s[52:53]
    v_cndmask_b32 v8, v8, v34, s[54:55]
    v_cndmask_b32 v9, v9, v38, s[54:55]
    v_cndmask_b32 v10, v10, v42, s[54:55]
    v_cndmask_b32 v11, v11, v46, s[54:55]
    v_cndmask_b32 v8, v8, v35, s[56:57]
    v_cndmask_b32 v9, v9, v39, s[56:57]
    v_cndmask_b32 v10, v10, v43, s[56:57]
    v_cndmask_b32 v11, v11, v47, s[56:57]
    v_add_f32_dpp v8, v8, v8 quad_perm:[1,0,3,2] row_mask:0xf bank_mask:0xf
    v_add_f32_dpp v9, v9, v9 quad_perm:[1,0,3,2] row_mask:0xf bank_mask:0xf
    v_add_f32_dpp v10, v10, v10 quad_perm:[1,0,3,2] row_mask:0xf bank_mask:0xf
    v_add_f32_dpp v11, v11, v11 quad_perm:[1,0,3,2] row_mask:0xf bank_mask:0xf
    v_add_f32_dpp v8, v8, v8 quad_perm:[2,3,0,1] row_mask:0xf bank_mask:0xf
    v_add_f32_dpp v9, v9, v9 quad_perm:[2,3,0,1] row_mask:0xf bank_mask:0xf
    v_add_f32_dpp v10, v10, v10 quad_perm:[2,3,0,1] row_mask:0xf bank_mask:0xf
    v_add_f32_dpp v11, v11, v11 quad_perm:[2,3,0,1] row_mask:0xf bank_mask:0xf
    s_mov_b32 s60, 0x3db504f3
    v_cvt_pk_bf16_f32 v48, v8, v9
    v_cvt_pk_bf16_f32 v49, v10, v11
    v_lshlrev_b32 v8, 16, v48
    v_and_b32 v9, 0xffff0000, v48
    v_lshlrev_b32 v10, 16, v49
    v_and_b32 v11, 0xffff0000, v49
    v_mul_f32 v8, s60, v8
    v_mul_f32 v9, s60, v9
    v_mul_f32 v10, s60, v10
    v_mul_f32 v11, s60, v11
    v_cvt_pk_bf16_f32 v48, v8, v9
    v_cvt_pk_bf16_f32 v49, v10, v11
    v_lshlrev_b32 v8, 16, v48
    v_and_b32 v9, 0xffff0000, v48
    v_lshlrev_b32 v10, 16, v49
    v_and_b32 v11, 0xffff0000, v49
    v_max3_f32 v48, v8, v9, v10
    v_max3_f32 v48, v48, v11, v20
    s_nop 1
    v_max_f32_dpp v48, v48, v48 row_ror:4 row_mask:0xf bank_mask:0xf
    s_nop 1
    v_max_f32_dpp v48, v48, v48 row_ror:8 row_mask:0xf bank_mask:0xf
    v_mov_b32 v49, v48
    s_nop 1
    v_permlane32_swap_b32 v48, v49
    v_max_f32 v48, v48, v49
    s_mov_b32 s60, 0x3fb8aa3b
    v_sub_f32 v50, v20, v48
    v_mul_f32 v50, s60, v50
    v_mul_f32 v49, s60, v48
    v_fma_f32 v8, v8, s60, -v49
    v_fma_f32 v9, v9, s60, -v49
    v_fma_f32 v10, v10, s60, -v49
    v_fma_f32 v11, v11, s60, -v49
    v_exp_f32 v50, v50
    v_exp_f32 v8, v8
    v_exp_f32 v9, v9
    v_exp_f32 v10, v10
    v_exp_f32 v11, v11
    v_mov_b32 v20, v48
    v_add_f32 v51, v8, v9
    v_add_f32 v52, v10, v11
    v_add_f32 v51, v51, v52
    s_nop 1
    v_add_f32_dpp v51, v51, v51 row_ror:4 row_mask:0xf bank_mask:0xf
    s_nop 1
    v_add_f32_dpp v51, v51, v51 row_ror:8 row_mask:0xf bank_mask:0xf
    v_mov_b32 v52, v51
    s_nop 1
    v_permlane32_swap_b32 v51, v52
    v_add_f32 v51, v51, v52
    v_fma_f32 v21, v21, v50, v51
    v_mov_b32 v52, v8
    v_mov_b32 v53, v9
    v_mov_b32 v54, v10
    v_mov_b32 v55, v11
    v_permlane32_swap_b32 v8, v52
    v_permlane32_swap_b32 v9, v53
    v_permlane32_swap_b32 v10, v54
    v_permlane32_swap_b32 v11, v55
    v_cvt_pk_bf16_f32 v56, v8, v52
    v_cvt_pk_bf16_f32 v57, v9, v53
    v_cvt_pk_bf16_f32 v58, v10, v54
    v_cvt_pk_bf16_f32 v59, v11, v55
    s_branch L_kq2_21
L_kq3_23:
    v_mfma_f32_16x16x32_bf16 v[32:35], v[24:27], v[96:99], 0
    v_mfma_f32_16x16x32_bf16 v[36:39], v[24:27], v[104:107], 0
    v_mfma_f32_16x16x32_bf16 v[40:43], v[24:27], v[112:115], 0
    v_mfma_f32_16x16x32_bf16 v[44:47], v[24:27], v[120:123], 0
    v_mfma_f32_16x16x32_bf16 v[32:35], v[28:31], v[100:103], v[32:35]
    v_mfma_f32_16x16x32_bf16 v[36:39], v[28:31], v[108:111], v[36:39]
    v_mfma_f32_16x16x32_bf16 v[40:43], v[28:31], v[116:119], v[40:43]
    v_mfma_f32_16x16x32_bf16 v[44:47], v[28:31], v[124:127], v[44:47]
    s_nop 4
    v_cndmask_b32 v8, v32, v33, s[52:53]
    v_cndmask_b32 v9, v36, v37, s[52:53]
    v_cndmask_b32 v10, v40, v41, s[52:53]
    v_cndmask_b32 v11, v44, v45, s[52:53]
    v_cndmask_b32 v8, v8, v34, s[54:55]
    v_cndmask_b32 v9, v9, v38, s[54:55]
    v_cndmask_b32 v10, v10, v42, s[54:55]
    v_cndmask_b32 v11, v11, v46, s[54:55]
    v_cndmask_b32 v8, v8, v35, s[56:57]
    v_cndmask_b32 v9, v9, v39, s[56:57]
    v_cndmask_b32 v10, v10, v43, s[56:57]
    v_cndmask_b32 v11, v11, v47, s[56:57]
    v_add_f32_dpp v8, v8, v8 quad_perm:[1,0,3,2] row_mask:0xf bank_mask:0xf
    v_add_f32_dpp v9, v9, v9 quad_perm:[1,0,3,2] row_mask:0xf bank_mask:0xf
    v_add_f32_dpp v10, v10, v10 quad_perm:[1,0,3,2] row_mask:0xf bank_mask:0xf
    v_add_f32_dpp v11, v11, v11 quad_perm:[1,0,3,2] row_mask:0xf bank_mask:0xf
    v_add_f32_dpp v8, v8, v8 quad_perm:[2,3,0,1] row_mask:0xf bank_mask:0xf
    v_add_f32_dpp v9, v9, v9 quad_perm:[2,3,0,1] row_mask:0xf bank_mask:0xf
    v_add_f32_dpp v10, v10, v10 quad_perm:[2,3,0,1] row_mask:0xf bank_mask:0xf
    v_add_f32_dpp v11, v11, v11 quad_perm:[2,3,0,1] row_mask:0xf bank_mask:0xf
    s_mov_b32 s60, 0x3db504f3
    v_cvt_pk_bf16_f32 v48, v8, v9
    v_cvt_pk_bf16_f32 v49, v10, v11
    v_lshlrev_b32 v8, 16, v48
    v_and_b32 v9, 0xffff0000, v48
    v_lshlrev_b32 v10, 16, v49
    v_and_b32 v11, 0xffff0000, v49
    v_mul_f32 v8, s60, v8
    v_mul_f32 v9, s60, v9
    v_mul_f32 v10, s60, v10
    v_mul_f32 v11, s60, v11
    v_cvt_pk_bf16_f32 v48, v8, v9
    v_cvt_pk_bf16_f32 v49, v10, v11
    v_lshlrev_b32 v8, 16, v48
    v_and_b32 v9, 0xffff0000, v48
    v_lshlrev_b32 v10, 16, v49
    v_and_b32 v11, 0xffff0000, v49
    v_max3_f32 v48, v8, v9, v10
    v_max3_f32 v48, v48, v11, v20
    s_nop 1
    v_max_f32_dpp v48, v48, v48 row_ror:4 row_mask:0xf bank_mask:0xf
    s_nop 1
    v_max_f32_dpp v48, v48, v48 row_ror:8 row_mask:0xf bank_mask:0xf
    v_mov_b32 v49, v48
    s_nop 1
    v_permlane32_swap_b32 v48, v49
    v_max_f32 v48, v48, v49
    s_mov_b32 s60, 0x3fb8aa3b
    v_sub_f32 v50, v20, v48
    v_mul_f32 v50, s60, v50
    v_mul_f32 v49, s60, v48
    v_fma_f32 v8, v8, s60, -v49
    v_fma_f32 v9, v9, s60, -v49
    v_fma_f32 v10, v10, s60, -v49
    v_fma_f32 v11, v11, s60, -v49
    v_exp_f32 v50, v50
    v_exp_f32 v8, v8
    v_exp_f32 v9, v9
    v_exp_f32 v10, v10
    v_exp_f32 v11, v11
    v_mov_b32 v20, v48
    v_add_f32 v51, v8, v9
    v_add_f32 v52, v10, v11
    v_add_f32 v51, v51, v52
    s_nop 1
    v_add_f32_dpp v51, v51, v51 row_ror:4 row_mask:0xf bank_mask:0xf
    s_nop 1
    v_add_f32_dpp v51, v51, v51 row_ror:8 row_mask:0xf bank_mask:0xf
    v_mov_b32 v52, v51
    s_nop 1
    v_permlane32_swap_b32 v51, v52
    v_add_f32 v51, v51, v52
    v_fma_f32 v21, v21, v50, v51
    v_mov_b32 v52, v8
    v_mov_b32 v53, v9
    v_mov_b32 v54, v10
    v_mov_b32 v55, v11
    v_permlane32_swap_b32 v8, v52
    v_permlane32_swap_b32 v9, v53
    v_permlane32_swap_b32 v10, v54
    v_permlane32_swap_b32 v11, v55
    v_cvt_pk_bf16_f32 v56, v8, v52
    v_cvt_pk_bf16_f32 v57, v9, v53
    v_cvt_pk_bf16_f32 v58, v10, v54
    v_cvt_pk_bf16_f32 v59, v11, v55
L_kq2_21:
    s_and_b32 s60, s43, 1
    s_lshl_b32 s61, s60, 7
    v_add_u32 v12, s61, v23
    s_mov_b32 exec_lo, 0x11111111
    s_mov_b32 exec_hi, 0
    ds_write_b128 v12, v[56:59] offset:3328
    s_mov_b64 exec, 0x10001
    v_lshrrev_b32 v13, 2, v1
    s_lshl_b32 s61, s31, 4
    s_lshl_b32 s60, s60, 3
    s_add_u32 s60, s60, s61
    v_add_u32 v14, s60, v13
    ds_write_b32 v14, v50 offset:5376
    s_mov_b64 exec, -1
    s_mov_b64 exec, 0x10001
    v_lshlrev_b32 v13, 1, v13
    v_add_u32 v13, s61, v13
    ds_write_b64 v13, v[20:21] offset:5504
    s_mov_b64 exec, -1
    s_waitcnt lgkmcnt(0)
    s_mov_b64 exec, 1
    ds_add_u32 v22, v3 offset:64
    s_mov_b64 exec, -1
    s_waitcnt lgkmcnt(0)
    s_mov_b64 exec, 1
    ds_add_u32 v22, v3 offset:416
    s_mov_b64 exec, -1
    s_add_u32 s43, s43, 1
    s_cmp_ge_u32 s31, 4
    s_cbranch_scc0 L_ksx_24
    s_cmp_ge_u32 s49, 16
    s_cbranch_scc1 L_tke_27
L_tk_25:
    s_waitcnt lgkmcnt(0)
    s_lshr_b32 s68, s66, 16
    s_cmp_eq_u32 s67, s28
    s_cselect_b32 s69, 1, 0
    s_and_b32 s61, s29, 0xffff
    s_cmp_eq_u32 s68, s61
    s_cselect_b32 s68, s69, 0
    s_cmp_lg_u32 s68, 0
    s_cbranch_scc1 L_tko_26
    s_sub_u32 s42, s42, 4096
    s_cbranch_scc1 L_tke_27
    s_mov_b32 s66, 1
    s_mov_b32 s67, 0
    s_atomic_add_x2 s[66:67], s[50:51], 0 glc
    s_branch L_tk_25
L_tko_26:
    s_and_b32 s66, s66, 0xffff
    s_cmp_ge_u32 s66, 64
    s_cbranch_scc1 L_tke_27
    s_add_u32 s64, s66, 64
    s_branch L_tkx_28
L_tke_27:
    s_mov_b32 s64, 65535
L_tkx_28:
    s_add_u32 s49, s49, 1
    v_mov_b32 v12, s64
    s_mov_b64 exec, 1
    ds_write_b32 v18, v12 offset:128
    s_mov_b64 exec, -1
    v_add_u32 v18, 4, v18
    s_cmp_eq_u32 s64, 65535
    s_cbranch_scc1 L_kfin_dyn
    s_setprio 1
    s_lshl_b32 s60, s64, 13
    s_add_u32 s60, s60, s3
    s_add_u32 s44, s6, s60
    s_addc_u32 s45, s7, 0
    global_load_dwordx4 v[64:67], v5, s[44:45] offset:0 nt
    global_load_dwordx4 v[68:71], v5, s[44:45] offset:1024 nt
    global_load_dwordx4 v[72:75], v5, s[44:45] offset:2048 nt
    global_load_dwordx4 v[76:79], v5, s[44:45] offset:3072 nt
    s_add_u32 s44, s44, 4096
    s_addc_u32 s45, s45, 0
    global_load_dwordx4 v[80:83], v5, s[44:45] offset:0 nt
    global_load_dwordx4 v[84:87], v5, s[44:45] offset:1024 nt
    global_load_dwordx4 v[88:91], v5, s[44:45] offset:2048 nt
    global_load_dwordx4 v[92:95], v5, s[44:45] offset:3072 nt
    s_setprio 2
    s_branch L_kloop
L_ksx_24:
    s_cmp_lg_u32 s65, 0
    s_cbranch_scc1 L_kloop
    s_branch L_ktail
L_kfin_dyn:
    s_waitcnt lgkmcnt(0)
    s_mov_b64 exec, 1
    ds_add_u32 v2, v3 offset:44
    s_mov_b64 exec, -1
L_kfin2:
    s_branch L_kend
L_ktail:
    v_lshlrev_b32 v12, 4, v16
    s_lshl_b32 s66, s31, 8
    v_add_u32 v12, s66, v12
    v_mul_u32_u24 v13, 4608, v17
    v_add_u32 v13, v13, v12
    v_mul_u32_u24 v14, 1152, v17
    v_add_u32 v14, v14, v12
    s_lshl_b32 s66, s38, 8
    s_lshl_b32 s67, s39, 4
    s_add_u32 s66, s66, s67
    s_mul_i32 s66, s66, 1152
    s_add_u32 s48, s12, s66
    s_addc_u32 s49, s13, 0
    s_mul_i32 s66, s2, 20736
    s_add_u32 s50, s20, s66
    s_addc_u32 s51, s21, 0
    v_mov_b32 v120, 0
    v_mov_b32 v121, 0
    v_mov_b32 v122, 0
    v_mov_b32 v123, 0
L_spin_29:
    ds_read_b32 v15, v2 offset:44
    s_waitcnt lgkmcnt(0)
    v_readfirstlane_b32 s60, v15
    s_nop 0
    s_cmp_ge_u32 s60, 4
    s_cbranch_scc1 L_spind_30
    s_sub_u32 s42, s42, 1
    s_cbranch_scc1 L_spind_30
    s_sleep 1
    s_branch L_spin_29
L_spind_30:
    s_setprio 0
    global_load_dwordx4 v[88:91], v13, s[48:49] offset:0 nt
    global_load_dwordx4 v[92:95], v13, s[48:49] offset:1152 nt
    global_load_dwordx4 v[96:99], v13, s[48:49] offset:2304 nt
    global_load_dwordx4 v[100:103], v13, s[48:49] offset:3456 nt
    global_load_dwordx4 v[104:107], v14, s[50:51] nt
    v_add_u32 v14, 4608, v14
    global_load_dwordx4 v[108:111], v14, s[50:51] nt
    v_add_u32 v14, 4608, v14
    global_load_dwordx4 v[112:115], v14, s[50:51] nt
    v_add_u32 v14, 4608, v14
    global_load_dwordx4 v[116:119], v14, s[50:51] nt
    v_add_u32 v14, 4608, v14
    s_mov_b32 exec_hi, 0
    global_load_dwordx4 v[120:123], v14, s[50:51] nt
    s_mov_b64 exec, -1
    s_mov_b64 exec, 1
    ds_add_u32 v2, v3 offset:52
    s_mov_b64 exec, -1
    s_setprio 2
    s_waitcnt vmcnt(0)
    v_perm_b32 v32, v92, v88, s36
    v_perm_b32 v33, v100, v96, s36
    v_perm_b32 v34, v92, v88, s37
    v_perm_b32 v35, v100, v96, s37
    v_perm_b32 v36, v93, v89, s36
    v_perm_b32 v37, v101, v97, s36
    v_perm_b32 v38, v93, v89, s37
    v_perm_b32 v39, v101, v97, s37
    v_perm_b32 v40, v94, v90, s36
    v_perm_b32 v41, v102, v98, s36
    v_perm_b32 v42, v94, v90, s37
    v_perm_b32 v43, v102, v98, s37
    v_perm_b32 v44, v95, v91, s36
    v_perm_b32 v45, v103, v99, s36
    v_perm_b32 v46, v95, v91, s37
    v_perm_b32 v47, v103, v99, s37
    v_perm_b32 v48, v108, v104, s36
    v_perm_b32 v49, v116, v112, s36
    v_and_b32 v50, 0xffff, v120
    v_mov_b32 v51, 0
    v_perm_b32 v52, v108, v104, s37
    v_perm_b32 v53, v116, v112, s37
    v_lshrrev_b32 v54, 16, v120
    v_mov_b32 v55, 0
    v_perm_b32 v56, v109, v105, s36
    v_perm_b32 v57, v117, v113, s36
    v_and_b32 v58, 0xffff, v121
    v_mov_b32 v59, 0
    v_perm_b32 v60, v109, v105, s37
    v_perm_b32 v61, v117, v113, s37
    v_lshrrev_b32 v62, 16, v121
    v_mov_b32 v63, 0
    v_perm_b32 v64, v110, v106, s36
    v_perm_b32 v65, v118, v114, s36
    v_and_b32 v66, 0xffff, v122
    v_mov_b32 v67, 0
    v_perm_b32 v68, v110, v106, s37
    v_perm_b32 v69, v118, v114, s37
    v_lshrrev_b32 v70, 16, v122
    v_mov_b32 v71, 0
    v_perm_b32 v72, v111, v107, s36
    v_perm_b32 v73, v119, v115, s36
    v_and_b32 v74, 0xffff, v123
    v_mov_b32 v75, 0
    v_perm_b32 v76, v111, v107, s37
    v_perm_b32 v77, v119, v115, s37
    v_lshrrev_b32 v78, 16, v123
    v_mov_b32 v79, 0
    v_and_b32 v4, 1, v1
    v_lshlrev_b32 v4, 2, v4
    v_add_u32 v4, v4, v17
    v_lshlrev_b32 v5, 3, v4
    v_lshlrev_b32 v6, 4, v4
    v_lshrrev_b32 v7, 2, v16
    v_lshl_add_u32 v7, v17, 2, v7
    s_mul_i32 s60, s31, 16
    v_add_u32 v7, s60, v7
    v_lshlrev_b32 v7, 14, v7
    v_and_b32 v8, 3, v16
    v_lshl_add_u32 v7, v8, 4, v7
    s_lshl_b32 s60, s2, 6
    s_add_u32 s60, s60, 1048576
    s_add_u32 s44, s26, s60
    s_addc_u32 s45, s27, 0
L_spin_31:
    ds_read_b32 v15, v2 offset:32
    s_waitcnt lgkmcnt(0)
    v_readfirstlane_b32 s60, v15
    s_nop 0
    s_cmp_ge_u32 s60, 1
    s_cbranch_scc1 L_spind_32
    s_sub_u32 s42, s42, 1
    s_cbranch_scc1 L_spind_32
    s_branch L_spin_31
L_spind_32:
    ds_read_b128 v[12:15], v6 offset:5696
    s_waitcnt lgkmcnt(0)
    v_mfma_f32_16x16x32_bf16 v[80:83], v[12:15], v[48:51], 0
    v_mfma_f32_16x16x32_bf16 v[84:87], v[12:15], v[52:55], 0
    v_mfma_f32_16x16x32_bf16 v[88:91], v[12:15], v[56:59], 0
    v_mfma_f32_16x16x32_bf16 v[92:95], v[12:15], v[60:63], 0
    v_mfma_f32_16x16x32_bf16 v[96:99], v[12:15], v[64:67], 0
    v_mfma_f32_16x16x32_bf16 v[100:103], v[12:15], v[68:71], 0
    v_mfma_f32_16x16x32_bf16 v[104:107], v[12:15], v[72:75], 0
    v_mfma_f32_16x16x32_bf16 v[108:111], v[12:15], v[76:79], 0
L_spin_33:
    ds_read_b32 v10, v2 offset:28
    s_waitcnt lgkmcnt(0)
    v_readfirstlane_b32 s60, v10
    s_nop 0
    s_cmp_ge_u32 s60, 1
    s_cbranch_scc1 L_spind_34
    s_sub_u32 s42, s42, 1
    s_cbranch_scc1 L_spind_34
    s_branch L_spin_33
L_spind_34:
    ds_read_b64 v[8:9], v5 offset:5632
    s_waitcnt lgkmcnt(0)
    v_mfma_f32_16x16x16_bf16 v[80:83], v[8:9], v[32:33], v[80:83]
    v_mfma_f32_16x16x16_bf16 v[84:87], v[8:9], v[34:35], v[84:87]
    v_mfma_f32_16x16x16_bf16 v[88:91], v[8:9], v[36:37], v[88:91]
    v_mfma_f32_16x16x16_bf16 v[92:95], v[8:9], v[38:39], v[92:95]
    v_mfma_f32_16x16x16_bf16 v[96:99], v[8:9], v[40:41], v[96:99]
    v_mfma_f32_16x16x16_bf16 v[100:103], v[8:9], v[42:43], v[100:103]
    v_mfma_f32_16x16x16_bf16 v[104:107], v[8:9], v[44:45], v[104:107]
    v_mfma_f32_16x16x16_bf16 v[108:111], v[8:9], v[46:47], v[108:111]
    s_mov_b32 s60, 0xffff0000
    s_mov_b32 s61, 0xffff0000
    s_mov_b32 s62, 0
    s_mov_b32 s63, -1
    v_cndmask_b32 v32, v80, v81, s[60:61]
    v_cndmask_b32 v33, v84, v85, s[60:61]
    v_cndmask_b32 v34, v88, v89, s[60:61]
    v_cndmask_b32 v35, v92, v93, s[60:61]
    v_cndmask_b32 v36, v96, v97, s[60:61]
    v_cndmask_b32 v37, v100, v101, s[60:61]
    v_cndmask_b32 v38, v104, v105, s[60:61]
    v_cndmask_b32 v39, v108, v109, s[60:61]
    v_cndmask_b32 v32, v32, v36, s[62:63]
    v_cndmask_b32 v33, v33, v37, s[62:63]
    v_cndmask_b32 v34, v34, v38, s[62:63]
    v_cndmask_b32 v35, v35, v39, s[62:63]
    v_bfi_b32 v32, v19, s32, v32
    v_bfi_b32 v33, v19, s33, v33
    v_bfi_b32 v34, v19, s34, v34
    v_bfi_b32 v35, v19, s35, v35
    global_store_dwordx4 v7, v[32:35], s[44:45] sc1
    s_waitcnt lgkmcnt(0)
    s_mov_b64 exec, 1
    ds_add_u32 v2, v3 offset:36
    s_mov_b64 exec, -1
L_kend:
    s_endpgm
L_vgu0:
    s_mul_i32 s62, s2, 911
    s_lshr_b32 s62, s62, 16
    s_mul_i32 s63, s62, 72
    s_sub_u32 s63, s2, s63
    s_mul_i32 s64, s62, 192
    s_mul_i32 s65, s31, 24
    s_add_u32 s64, s64, s65
    s_mul_i32 s65, s64, 9216
    s_lshl_b32 s66, s63, 7
    s_add_u32 s65, s65, s66
    v_mul_u32_u24 v4, 55296, v17
    v_and_b32 v5, 7, v16
    v_lshl_add_u32 v4, v5, 4, v4
    v_add_u32 v4, s65, v4
    s_mov_b32 s58, 0x00ff00ff
    s_mov_b32 s59, 0x00ff00ff
    v_mov_b32 v8, s16
    v_mov_b32 v9, s17
    v_mov_b32 v10, s18
    v_mov_b32 v11, s19
    v_cndmask_b32 v8, v10, v8, s[58:59]
    v_cndmask_b32 v9, v11, v9, s[58:59]
    v_add_co_u32 v8, vcc, v8, v4
    s_nop 1
    v_addc_co_u32 v9, vcc, 0, v9, vcc
    s_mov_b32 s46, 9216
    s_mov_b32 s47, 0
    v_lshlrev_b32 v5, 4, v1
    s_lshl_b32 s67, s41, 3
    s_lshl_b32 s61, s31, 1
    s_add_u32 s67, s67, s61
L_spin_40:
    ds_read_b32 v12, v2 offset:8
    s_waitcnt lgkmcnt(0)
    v_readfirstlane_b32 s60, v12
    s_nop 0
    s_cmp_ge_u32 s60, 4
    s_cbranch_scc1 L_spind_41
    s_sub_u32 s42, s42, 1
    s_cbranch_scc1 L_spind_41
    s_branch L_spin_40
L_spind_41:
    s_setprio 2
    s_cmp_ge_u32 s2, 216
    s_cbranch_scc1 L_nogu_42
    global_load_dwordx4 v[96:99], v[8:9], off nt
    v_lshl_add_u64 v[8:9], v[8:9], 0, s[46:47]
    global_load_dwordx4 v[100:103], v[8:9], off nt
    v_lshl_add_u64 v[8:9], v[8:9], 0, s[46:47]
    global_load_dwordx4 v[104:107], v[8:9], off nt
    v_lshl_add_u64 v[8:9], v[8:9], 0, s[46:47]
    global_load_dwordx4 v[108:111], v[8:9], off nt
    v_lshl_add_u64 v[8:9], v[8:9], 0, s[46:47]
    global_load_dwordx4 v[112:115], v[8:9], off nt
    v_lshl_add_u64 v[8:9], v[8:9], 0, s[46:47]
    global_load_dwordx4 v[116:119], v[8:9], off nt
L_nogu_42:
    s_waitcnt lgkmcnt(0)
    s_mov_b64 exec, 1
    ds_add_u32 v2, v3 offset:12
    s_mov_b64 exec, -1
    s_cmp_ge_u32 s31, 4
    s_cbranch_scc1 L_nost_43
L_spin_44:
    ds_read_b32 v12, v2 offset:12
    s_waitcnt lgkmcnt(0)
    v_readfirstlane_b32 s60, v12
    s_nop 0
    s_cmp_ge_u32 s60, 8
    s_cbranch_scc1 L_spind_45
    s_sub_u32 s42, s42, 1
    s_cbranch_scc1 L_spind_45
    s_branch L_spin_44
L_spind_45:
    s_lshl_b32 s60, s67, 13
    s_add_u32 s60, s60, s3
    s_add_u32 s44, s8, s60
    s_addc_u32 s45, s9, 0
    global_load_dwordx4 v[64:67], v5, s[44:45] offset:0 nt
    global_load_dwordx4 v[68:71], v5, s[44:45] offset:1024 nt
    global_load_dwordx4 v[72:75], v5, s[44:45] offset:2048 nt
    global_load_dwordx4 v[76:79], v5, s[44:45] offset:3072 nt
    s_add_u32 s44, s44, 4096
    s_addc_u32 s45, s45, 0
    global_load_dwordx4 v[80:83], v5, s[44:45] offset:0 nt
    global_load_dwordx4 v[84:87], v5, s[44:45] offset:1024 nt
    global_load_dwordx4 v[88:91], v5, s[44:45] offset:2048 nt
    global_load_dwordx4 v[92:95], v5, s[44:45] offset:3072 nt
L_nost_43:
    s_setprio 3
    s_cmp_ge_u32 s2, 216
    s_cbranch_scc1 L_gud_46
    v_and_b32 v4, 1, v1
    v_mul_u32_u24 v4, 1152, v4
    v_mul_u32_u24 v6, 12, v17
    v_add_u32 v4, v4, v6
    s_lshl_b32 s64, s64, 1
    v_add_u32 v4, s64, v4
L_spin_47:
    ds_read_b32 v24, v2 offset:0
    s_waitcnt lgkmcnt(0)
    v_readfirstlane_b32 s60, v24
    s_nop 0
    s_cmp_ge_u32 s60, 2
    s_cbranch_scc1 L_spind_48
    s_sub_u32 s42, s42, 1
    s_cbranch_scc1 L_spind_48
    s_branch L_spin_47
L_spind_48:
    ds_read_b32 v24, v4 offset:512
    ds_read_b32 v25, v4 offset:516
    ds_read_b32 v26, v4 offset:520
    v_mov_b32 v27, 0
    v_mov_b32 v11, 0
    v_mov_b32 v15, 0
    s_cmp_ge_u32 s31, 4
    s_cbranch_scc1 L_w0_50
    s_waitcnt vmcnt(8) lgkmcnt(0)
    s_branch L_w8_49
L_w0_50:
    s_waitcnt vmcnt(0) lgkmcnt(0)
L_w8_49:
    v_perm_b32 v8, v100, v96, s36
    v_perm_b32 v9, v108, v104, s36
    v_perm_b32 v10, v116, v112, s36
    v_perm_b32 v12, v100, v96, s37
    v_perm_b32 v13, v108, v104, s37
    v_perm_b32 v14, v116, v112, s37
    v_mfma_f32_16x16x32_bf16 v[32:35], v[24:27], v[8:11], 0
    v_perm_b32 v8, v101, v97, s36
    v_perm_b32 v9, v109, v105, s36
    v_perm_b32 v10, v117, v113, s36
    v_mfma_f32_16x16x32_bf16 v[36:39], v[24:27], v[12:15], 0
    v_perm_b32 v12, v101, v97, s37
    v_perm_b32 v13, v109, v105, s37
    v_perm_b32 v14, v117, v113, s37
    v_mfma_f32_16x16x32_bf16 v[40:43], v[24:27], v[8:11], 0
    v_perm_b32 v8, v102, v98, s36
    v_perm_b32 v9, v110, v106, s36
    v_perm_b32 v10, v118, v114, s36
    v_mfma_f32_16x16x32_bf16 v[44:47], v[24:27], v[12:15], 0
    v_perm_b32 v12, v102, v98, s37
    v_perm_b32 v13, v110, v106, s37
    v_perm_b32 v14, v118, v114, s37
    v_mfma_f32_16x16x32_bf16 v[48:51], v[24:27], v[8:11], 0
    v_perm_b32 v8, v103, v99, s36
    v_perm_b32 v9, v111, v107, s36
    v_perm_b32 v10, v119, v115, s36
    v_mfma_f32_16x16x32_bf16 v[52:55], v[24:27], v[12:15], 0
    v_perm_b32 v12, v103, v99, s37
    v_perm_b32 v13, v111, v107, s37
    v_perm_b32 v14, v119, v115, s37
    v_mfma_f32_16x16x32_bf16 v[56:59], v[24:27], v[8:11], 0
    s_nop 0
    v_mfma_f32_16x16x32_bf16 v[60:63], v[24:27], v[12:15], 0
    v_mov_b32 v96, v32
    v_mov_b32 v97, v36
    v_mov_b32 v98, v40
    v_mov_b32 v99, v44
    v_mov_b32 v100, v48
    v_mov_b32 v101, v52
    v_mov_b32 v102, v56
    s_nop 0
    v_mov_b32 v103, v60
    v_mov_b32 v104, v33
    v_mov_b32 v105, v37
    v_mov_b32 v106, v41
    v_mov_b32 v107, v45
    v_mov_b32 v108, v49
    v_mov_b32 v109, v53
    v_mov_b32 v110, v57
    v_mov_b32 v111, v61
    v_lshlrev_b32 v4, 5, v16
    s_lshl_b32 s60, s31, 10
    v_add_u32 v4, s60, v4
    s_mov_b64 exec, 0xffff
    ds_write_b128 v4, v[96:99] offset:24576
    ds_write_b128 v4, v[100:103] offset:24592
    ds_write_b128 v4, v[104:107] offset:25088
    ds_write_b128 v4, v[108:111] offset:25104
    s_mov_b64 exec, -1
    s_waitcnt lgkmcnt(0)
    s_mov_b64 exec, 1
    ds_add_rtn_u32 v4, v2, v3 offset:24
    s_mov_b64 exec, -1
    s_waitcnt lgkmcnt(0)
    v_readfirstlane_b32 s60, v4
    s_nop 0
    s_cmp_lg_u32 s60, 7
    s_cbranch_scc1 L_gud_46
    s_mul_i32 s60, s62, 73728
    s_lshl_b32 s61, s63, 8
    s_add_u32 s60, s60, s61
    s_add_u32 s60, s60, 655360
    s_add_u32 s44, s26, s60
    s_addc_u32 s45, s27, 0
    v_mul_u32_u24 v7, 18432, v17
    v_lshl_add_u32 v7, v16, 4, v7
    v_and_b32 v6, 1, v17
    v_lshlrev_b32 v6, 9, v6
    v_lshrrev_b32 v8, 1, v17
    v_lshl_add_u32 v6, v8, 8, v6
    v_lshl_add_u32 v6, v16, 4, v6
    ds_read_b128 v[96:99], v6 offset:24576
    ds_read_b128 v[100:103], v6 offset:25600
    ds_read_b128 v[104:107], v6 offset:26624
    ds_read_b128 v[108:111], v6 offset:27648
    ds_read_b128 v[112:115], v6 offset:28672
    ds_read_b128 v[116:119], v6 offset:29696
    ds_read_b128 v[120:123], v6 offset:30720
    ds_read_b128 v[124:127], v6 offset:31744
    s_waitcnt lgkmcnt(0)
    v_add_f32 v96, v96, v100
    v_add_f32 v97, v97, v101
    v_add_f32 v98, v98, v102
    v_add_f32 v99, v99, v103
    v_add_f32 v96, v96, v104
    v_add_f32 v97, v97, v105
    v_add_f32 v98, v98, v106
    v_add_f32 v99, v99, v107
    v_add_f32 v96, v96, v108
    v_add_f32 v97, v97, v109
    v_add_f32 v98, v98, v110
    v_add_f32 v99, v99, v111
    v_add_f32 v96, v96, v112
    v_add_f32 v97, v97, v113
    v_add_f32 v98, v98, v114
    v_add_f32 v99, v99, v115
    v_add_f32 v96, v96, v116
    v_add_f32 v97, v97, v117
    v_add_f32 v98, v98, v118
    v_add_f32 v99, v99, v119
    v_add_f32 v96, v96, v120
    v_add_f32 v97, v97, v121
    v_add_f32 v98, v98, v122
    v_add_f32 v99, v99, v123
    v_add_f32 v96, v96, v124
    v_add_f32 v97, v97, v125
    v_add_f32 v98, v98, v126
    v_add_f32 v99, v99, v127
    v_bfi_b32 v96, v19, s32, v96
    v_bfi_b32 v97, v19, s33, v97
    v_bfi_b32 v98, v19, s34, v98
    v_bfi_b32 v99, v19, s35, v99
    global_store_dwordx4 v7, v[96:99], s[44:45] sc1
    s_mov_b32 s48, 1
    s_branch L_vpv0
L_gud_46:
    s_mov_b32 s48, 0
L_vpv0:
    v_and_b32 v6, 1, v1
    v_lshlrev_b32 v6, 2, v6
    v_add_u32 v6, v6, v17
    v_lshlrev_b32 v6, 4, v6
    s_lshl_b32 s60, s31, 8
    v_add_u32 v6, s60, v6
    s_lshl_b32 s60, s31, 2
    v_mov_b32 v22, s60
    s_lshl_b32 s60, s31, 4
    v_mov_b32 v23, s60
    v_mov_b32 v32, 0
    v_mov_b32 v33, 0
    v_mov_b32 v34, 0
    v_mov_b32 v35, 0
    v_mov_b32 v36, 0
    v_mov_b32 v37, 0
    v_mov_b32 v38, 0
    v_mov_b32 v39, 0
    v_mov_b32 v40, 0
    v_mov_b32 v41, 0
    v_mov_b32 v42, 0
    v_mov_b32 v43, 0
    v_mov_b32 v44, 0
    v_mov_b32 v45, 0
    v_mov_b32 v46, 0
    v_mov_b32 v47, 0
    v_mov_b32 v48, 0
    v_mov_b32 v49, 0
    v_mov_b32 v50, 0
    v_mov_b32 v51, 0
    v_mov_b32 v52, 0
    v_mov_b32 v53, 0
    v_mov_b32 v54, 0
    v_mov_b32 v55, 0
    v_mov_b32 v56, 0
    v_mov_b32 v57, 0
    v_mov_b32 v58, 0
    v_mov_b32 v59, 0
    v_mov_b32 v60, 0
    v_mov_b32 v61, 0
    v_mov_b32 v62, 0
    v_mov_b32 v63, 0
    s_mov_b32 s43, 0
    s_cmp_ge_u32 s31, 4
    s_cbranch_scc1 L_vdyn0
    s_add_u32 s67, s67, 1
    s_setprio 2
    s_lshl_b32 s60, s67, 13
    s_add_u32 s60, s60, s3
    s_add_u32 s44, s8, s60
    s_addc_u32 s45, s9, 0
    global_load_dwordx4 v[96:99], v5, s[44:45] offset:0 nt
    global_load_dwordx4 v[100:103], v5, s[44:45] offset:1024 nt
    global_load_dwordx4 v[104:107], v5, s[44:45] offset:2048 nt
    global_load_dwordx4 v[108:111], v5, s[44:45] offset:3072 nt
    s_add_u32 s44, s44, 4096
    s_addc_u32 s45, s45, 0
    global_load_dwordx4 v[112:115], v5, s[44:45] offset:0 nt
    global_load_dwordx4 v[116:119], v5, s[44:45] offset:1024 nt
    global_load_dwordx4 v[120:123], v5, s[44:45] offset:2048 nt
    global_load_dwordx4 v[124:127], v5, s[44:45] offset:3072 nt
    s_setprio 3
    s_mov_b32 s65, 1
    s_branch L_vloop
L_vdyn0:
    s_sub_u32 s60, s31, 4
    s_mul_i32 s60, s60, 72
    v_mov_b32 v18, s60
L_vnext:
L_spin_51:
    ds_read_b32 v12, v18 offset:128
    s_waitcnt lgkmcnt(0)
    v_readfirstlane_b32 s67, v12
    s_nop 0
    s_cmp_lg_u32 s67, 0
    s_cbranch_scc1 L_spind_52
    s_sub_u32 s42, s42, 1
    s_cbranch_scc1 L_spind_52
    s_branch L_spin_51
L_spind_52:
    v_add_u32 v18, 4, v18
    s_cmp_ge_u32 s67, 128
    s_cbranch_scc1 L_vfin
    s_cmp_eq_u32 s43, 0
    s_cbranch_scc1 L_vp1_53
    s_setprio 1
    s_branch L_vp2_54
L_vp1_53:
    s_setprio 1
L_vp2_54:
    s_lshl_b32 s60, s67, 13
    s_add_u32 s60, s60, s3
    s_add_u32 s44, s8, s60
    s_addc_u32 s45, s9, 0
    global_load_dwordx4 v[64:67], v5, s[44:45] offset:0 nt
    global_load_dwordx4 v[68:71], v5, s[44:45] offset:1024 nt
    global_load_dwordx4 v[72:75], v5, s[44:45] offset:2048 nt
    global_load_dwordx4 v[76:79], v5, s[44:45] offset:3072 nt
    s_add_u32 s44, s44, 4096
    s_addc_u32 s45, s45, 0
    global_load_dwordx4 v[80:83], v5, s[44:45] offset:0 nt
    global_load_dwordx4 v[84:87], v5, s[44:45] offset:1024 nt
    global_load_dwordx4 v[88:91], v5, s[44:45] offset:2048 nt
    global_load_dwordx4 v[92:95], v5, s[44:45] offset:3072 nt
    s_setprio 3
L_vloop:
    s_cmp_ge_u32 s31, 4
    s_cbranch_scc0 L_vst_55
    s_waitcnt vmcnt(0)
    s_branch L_vgo_56
L_vst_55:
    s_cmp_lg_u32 s43, 0
    s_cbranch_scc1 L_vw1_57
    s_waitcnt vmcnt(8)
    s_branch L_vgo_56
L_vw1_57:
    s_waitcnt vmcnt(0)
    s_mov_b32 s65, 0
L_vgo_56:
    s_add_u32 s61, s43, 1
L_spin_58:
    ds_read_b32 v12, v22 offset:64
    s_waitcnt lgkmcnt(0)
    v_readfirstlane_b32 s60, v12
    s_nop 0
    s_cmp_ge_u32 s60, s61
    s_cbranch_scc1 L_spind_59
    s_sub_u32 s42, s42, 1
    s_cbranch_scc1 L_spind_59
    s_branch L_spin_58
L_spind_59:
    s_and_b32 s60, s43, 1
    s_lshl_b32 s61, s60, 7
    v_add_u32 v12, s61, v6
    s_lshl_b32 s61, s60, 3
    v_add_u32 v13, s61, v23
    ds_read_b128 v[24:27], v12 offset:3328
    ds_read_b64 v[28:29], v13 offset:5376
    s_waitcnt lgkmcnt(0)
    s_mov_b64 exec, 1
    ds_add_u32 v22, v3 offset:96
    s_mov_b64 exec, -1
    v_mul_f32 v32, v32, v28
    v_mul_f32 v33, v33, v29
    v_mul_f32 v36, v36, v28
    v_mul_f32 v37, v37, v29
    v_mul_f32 v40, v40, v28
    v_mul_f32 v41, v41, v29
    v_mul_f32 v44, v44, v28
    v_mul_f32 v45, v45, v29
    v_mul_f32 v48, v48, v28
    v_mul_f32 v49, v49, v29
    v_mul_f32 v52, v52, v28
    v_mul_f32 v53, v53, v29
    v_mul_f32 v56, v56, v28
    v_mul_f32 v57, v57, v29
    v_mul_f32 v60, v60, v28
    v_mul_f32 v61, v61, v29
    s_cmp_ge_u32 s31, 4
    s_cbranch_scc1 L_pv0_62
    s_bitcmp1_b32 s43, 0
    s_cbranch_scc1 L_pv1_60
    v_perm_b32 v8, v68, v64, s36
    v_perm_b32 v9, v76, v72, s36
    v_perm_b32 v10, v84, v80, s36
    v_perm_b32 v11, v92, v88, s36
    v_perm_b32 v12, v68, v64, s37
    v_perm_b32 v13, v76, v72, s37
    v_perm_b32 v14, v84, v80, s37
    v_perm_b32 v15, v92, v88, s37
    v_mfma_f32_16x16x32_bf16 v[32:35], v[24:27], v[8:11], v[32:35]
    v_perm_b32 v8, v69, v65, s36
    v_perm_b32 v9, v77, v73, s36
    v_perm_b32 v10, v85, v81, s36
    v_perm_b32 v11, v93, v89, s36
    v_mfma_f32_16x16x32_bf16 v[36:39], v[24:27], v[12:15], v[36:39]
    v_perm_b32 v12, v69, v65, s37
    v_perm_b32 v13, v77, v73, s37
    v_perm_b32 v14, v85, v81, s37
    v_perm_b32 v15, v93, v89, s37
    v_mfma_f32_16x16x32_bf16 v[40:43], v[24:27], v[8:11], v[40:43]
    v_perm_b32 v8, v70, v66, s36
    v_perm_b32 v9, v78, v74, s36
    v_perm_b32 v10, v86, v82, s36
    v_perm_b32 v11, v94, v90, s36
    v_mfma_f32_16x16x32_bf16 v[44:47], v[24:27], v[12:15], v[44:47]
    v_perm_b32 v12, v70, v66, s37
    v_perm_b32 v13, v78, v74, s37
    v_perm_b32 v14, v86, v82, s37
    v_perm_b32 v15, v94, v90, s37
    v_mfma_f32_16x16x32_bf16 v[48:51], v[24:27], v[8:11], v[48:51]
    v_perm_b32 v8, v71, v67, s36
    v_perm_b32 v9, v79, v75, s36
    v_perm_b32 v10, v87, v83, s36
    v_perm_b32 v11, v95, v91, s36
    v_mfma_f32_16x16x32_bf16 v[52:55], v[24:27], v[12:15], v[52:55]
    v_perm_b32 v12, v71, v67, s37
    v_perm_b32 v13, v79, v75, s37
    v_perm_b32 v14, v87, v83, s37
    v_perm_b32 v15, v95, v91, s37
    v_mfma_f32_16x16x32_bf16 v[56:59], v[24:27], v[8:11], v[56:59]
    s_nop 0
    v_mfma_f32_16x16x32_bf16 v[60:63], v[24:27], v[12:15], v[60:63]
    s_branch L_pv2_61
L_pv0_62:
    v_perm_b32 v8, v68, v64, s36
    v_perm_b32 v9, v76, v72, s36
    v_perm_b32 v10, v84, v80, s36
    v_perm_b32 v11, v92, v88, s36
    v_perm_b32 v12, v68, v64, s37
    v_perm_b32 v13, v76, v72, s37
    v_perm_b32 v14, v84, v80, s37
    v_perm_b32 v15, v92, v88, s37
    v_mfma_f32_16x16x32_bf16 v[32:35], v[24:27], v[8:11], v[32:35]
    v_perm_b32 v8, v69, v65, s36
    v_perm_b32 v9, v77, v73, s36
    v_perm_b32 v10, v85, v81, s36
    v_perm_b32 v11, v93, v89, s36
    v_mfma_f32_16x16x32_bf16 v[36:39], v[24:27], v[12:15], v[36:39]
    v_perm_b32 v12, v69, v65, s37
    v_perm_b32 v13, v77, v73, s37
    v_perm_b32 v14, v85, v81, s37
    v_perm_b32 v15, v93, v89, s37
    v_mfma_f32_16x16x32_bf16 v[40:43], v[24:27], v[8:11], v[40:43]
    v_perm_b32 v8, v70, v66, s36
    v_perm_b32 v9, v78, v74, s36
    v_perm_b32 v10, v86, v82, s36
    v_perm_b32 v11, v94, v90, s36
    v_mfma_f32_16x16x32_bf16 v[44:47], v[24:27], v[12:15], v[44:47]
    v_perm_b32 v12, v70, v66, s37
    v_perm_b32 v13, v78, v74, s37
    v_perm_b32 v14, v86, v82, s37
    v_perm_b32 v15, v94, v90, s37
    v_mfma_f32_16x16x32_bf16 v[48:51], v[24:27], v[8:11], v[48:51]
    v_perm_b32 v8, v71, v67, s36
    v_perm_b32 v9, v79, v75, s36
    v_perm_b32 v10, v87, v83, s36
    v_perm_b32 v11, v95, v91, s36
    v_mfma_f32_16x16x32_bf16 v[52:55], v[24:27], v[12:15], v[52:55]
    v_perm_b32 v12, v71, v67, s37
    v_perm_b32 v13, v79, v75, s37
    v_perm_b32 v14, v87, v83, s37
    v_perm_b32 v15, v95, v91, s37
    v_mfma_f32_16x16x32_bf16 v[56:59], v[24:27], v[8:11], v[56:59]
    s_nop 0
    v_mfma_f32_16x16x32_bf16 v[60:63], v[24:27], v[12:15], v[60:63]
    s_branch L_pv2_61
L_pv1_60:
    v_perm_b32 v8, v100, v96, s36
    v_perm_b32 v9, v108, v104, s36
    v_perm_b32 v10, v116, v112, s36
    v_perm_b32 v11, v124, v120, s36
    v_perm_b32 v12, v100, v96, s37
    v_perm_b32 v13, v108, v104, s37
    v_perm_b32 v14, v116, v112, s37
    v_perm_b32 v15, v124, v120, s37
    v_mfma_f32_16x16x32_bf16 v[32:35], v[24:27], v[8:11], v[32:35]
    v_perm_b32 v8, v101, v97, s36
    v_perm_b32 v9, v109, v105, s36
    v_perm_b32 v10, v117, v113, s36
    v_perm_b32 v11, v125, v121, s36
    v_mfma_f32_16x16x32_bf16 v[36:39], v[24:27], v[12:15], v[36:39]
    v_perm_b32 v12, v101, v97, s37
    v_perm_b32 v13, v109, v105, s37
    v_perm_b32 v14, v117, v113, s37
    v_perm_b32 v15, v125, v121, s37
    v_mfma_f32_16x16x32_bf16 v[40:43], v[24:27], v[8:11], v[40:43]
    v_perm_b32 v8, v102, v98, s36
    v_perm_b32 v9, v110, v106, s36
    v_perm_b32 v10, v118, v114, s36
    v_perm_b32 v11, v126, v122, s36
    v_mfma_f32_16x16x32_bf16 v[44:47], v[24:27], v[12:15], v[44:47]
    v_perm_b32 v12, v102, v98, s37
    v_perm_b32 v13, v110, v106, s37
    v_perm_b32 v14, v118, v114, s37
    v_perm_b32 v15, v126, v122, s37
    v_mfma_f32_16x16x32_bf16 v[48:51], v[24:27], v[8:11], v[48:51]
    v_perm_b32 v8, v103, v99, s36
    v_perm_b32 v9, v111, v107, s36
    v_perm_b32 v10, v119, v115, s36
    v_perm_b32 v11, v127, v123, s36
    v_mfma_f32_16x16x32_bf16 v[52:55], v[24:27], v[12:15], v[52:55]
    v_perm_b32 v12, v103, v99, s37
    v_perm_b32 v13, v111, v107, s37
    v_perm_b32 v14, v119, v115, s37
    v_perm_b32 v15, v127, v123, s37
    v_mfma_f32_16x16x32_bf16 v[56:59], v[24:27], v[8:11], v[56:59]
    s_nop 0
    v_mfma_f32_16x16x32_bf16 v[60:63], v[24:27], v[12:15], v[60:63]
L_pv2_61:
    s_add_u32 s43, s43, 1
    s_cmp_ge_u32 s31, 4
    s_cbranch_scc1 L_vnext
    s_cmp_lg_u32 s65, 0
    s_cbranch_scc1 L_vloop
L_vfin:
L_spin_63:
    ds_read_b32 v12, v22 offset:416
    s_waitcnt lgkmcnt(0)
    v_readfirstlane_b32 s60, v12
    s_nop 0
    s_cmp_ge_u32 s60, s43
    s_cbranch_scc1 L_spind_64
    s_sub_u32 s42, s42, 1
    s_cbranch_scc1 L_spind_64
    s_branch L_spin_63
L_spind_64:
    v_mov_b32 v64, v32
    v_mov_b32 v65, v36
    v_mov_b32 v66, v40
    v_mov_b32 v67, v44
    v_mov_b32 v68, v48
    v_mov_b32 v69, v52
    v_mov_b32 v70, v56
    v_mov_b32 v71, v60
    v_mov_b32 v72, v33
    v_mov_b32 v73, v37
    v_mov_b32 v74, v41
    v_mov_b32 v75, v45
    v_mov_b32 v76, v49
    v_mov_b32 v77, v53
    v_mov_b32 v78, v57
    v_mov_b32 v79, v61
    v_lshlrev_b32 v4, 5, v16
    s_lshl_b32 s60, s31, 10
    v_add_u32 v4, s60, v4
    s_mov_b64 exec, 0xffff
    ds_write_b128 v4, v[64:67] offset:16384
    ds_write_b128 v4, v[68:71] offset:16400
    ds_write_b128 v4, v[72:75] offset:16896
    ds_write_b128 v4, v[76:79] offset:16912
    s_mov_b64 exec, -1
    s_waitcnt lgkmcnt(0)
    s_mov_b64 exec, 1
    ds_add_rtn_u32 v4, v2, v3 offset:20
    s_mov_b64 exec, -1
    s_waitcnt lgkmcnt(0)
    v_readfirstlane_b32 s60, v4
    s_nop 0
    s_cmp_lg_u32 s60, 7
    s_cbranch_scc1 L_vrole
    v_and_b32 v7, 7, v1
    v_lshlrev_b32 v7, 4, v7
    v_lshrrev_b32 v8, 5, v1
    v_lshl_add_u32 v7, v8, 3, v7
    ds_read_b64 v[28:29], v7 offset:5504
    v_lshlrev_b32 v4, 4, v1
    ds_read_b128 v[64:67], v4 offset:16384
    ds_read_b128 v[68:71], v4 offset:17408
    ds_read_b128 v[72:75], v4 offset:18432
    ds_read_b128 v[76:79], v4 offset:19456
    ds_read_b128 v[80:83], v4 offset:20480
    ds_read_b128 v[84:87], v4 offset:21504
    ds_read_b128 v[88:91], v4 offset:22528
    ds_read_b128 v[92:95], v4 offset:23552
    s_lshl_b32 s60, s38, 4
    s_add_u32 s60, s60, s39
    s_mul_i32 s60, s60, 1152
    s_add_u32 s60, s60, 327680
    s_add_u32 s44, s26, s60
    s_addc_u32 s45, s27, 0
    s_waitcnt lgkmcnt(8)
    v_mov_b32 v30, v28
    s_nop 1
    v_max_f32_dpp v30, v30, v30 quad_perm:[1,0,3,2] row_mask:0xf bank_mask:0xf
    s_nop 1
    v_max_f32_dpp v30, v30, v30 quad_perm:[2,3,0,1] row_mask:0xf bank_mask:0xf
    s_nop 1
    v_max_f32_dpp v30, v30, v30 row_half_mirror row_mask:0xf bank_mask:0xf
    v_and_b32 v30, 0xfffff000, v30
    v_sub_f32 v31, v28, v30
    v_mul_f32 v31, 0x3fb8aa3b, v31
    v_exp_f32 v31, v31
    s_nop 0
    v_mul_f32 v29, v31, v29
    s_nop 1
    v_add_f32_dpp v29, v29, v29 quad_perm:[1,0,3,2] row_mask:0xf bank_mask:0xf
    s_nop 1
    v_add_f32_dpp v29, v29, v29 quad_perm:[2,3,0,1] row_mask:0xf bank_mask:0xf
    s_nop 1
    v_add_f32_dpp v29, v29, v29 row_half_mirror row_mask:0xf bank_mask:0xf
    s_waitcnt lgkmcnt(0)
    v_mov_b32_dpp v8, v31 row_newbcast:0 row_mask:0xf bank_mask:0xf
    v_mul_f32 v64, v64, v8
    v_mul_f32 v65, v65, v8
    v_mul_f32 v66, v66, v8
    v_mul_f32 v67, v67, v8
    v_mov_b32_dpp v9, v31 row_newbcast:1 row_mask:0xf bank_mask:0xf
    v_fmac_f32 v64, v68, v9
    v_fmac_f32 v65, v69, v9
    v_fmac_f32 v66, v70, v9
    v_fmac_f32 v67, v71, v9
    v_mov_b32_dpp v10, v31 row_newbcast:2 row_mask:0xf bank_mask:0xf
    v_fmac_f32 v64, v72, v10
    v_fmac_f32 v65, v73, v10
    v_fmac_f32 v66, v74, v10
    v_fmac_f32 v67, v75, v10
    v_mov_b32_dpp v11, v31 row_newbcast:3 row_mask:0xf bank_mask:0xf
    v_fmac_f32 v64, v76, v11
    v_fmac_f32 v65, v77, v11
    v_fmac_f32 v66, v78, v11
    v_fmac_f32 v67, v79, v11
    v_mov_b32_dpp v8, v31 row_newbcast:4 row_mask:0xf bank_mask:0xf
    v_fmac_f32 v64, v80, v8
    v_fmac_f32 v65, v81, v8
    v_fmac_f32 v66, v82, v8
    v_fmac_f32 v67, v83, v8
    v_mov_b32_dpp v9, v31 row_newbcast:5 row_mask:0xf bank_mask:0xf
    v_fmac_f32 v64, v84, v9
    v_fmac_f32 v65, v85, v9
    v_fmac_f32 v66, v86, v9
    v_fmac_f32 v67, v87, v9
    v_mov_b32_dpp v10, v31 row_newbcast:6 row_mask:0xf bank_mask:0xf
    v_fmac_f32 v64, v88, v10
    v_fmac_f32 v65, v89, v10
    v_fmac_f32 v66, v90, v10
    v_fmac_f32 v67, v91, v10
    v_mov_b32_dpp v11, v31 row_newbcast:7 row_mask:0xf bank_mask:0xf
    v_fmac_f32 v64, v92, v11
    v_fmac_f32 v65, v93, v11
    v_fmac_f32 v66, v94, v11
    v_fmac_f32 v67, v95, v11
    v_bfi_b32 v64, v19, s32, v64
    v_bfi_b32 v65, v19, s33, v65
    v_bfi_b32 v66, v19, s34, v66
    v_bfi_b32 v67, v19, s35, v67
    global_store_dwordx4 v4, v[64:67], s[44:45] sc1
    v_mov_b32 v68, v30
    v_mov_b32 v69, v29
    v_mov_b32 v70, 0
    v_mov_b32 v71, 0
    v_bfi_b32 v68, v19, s32, v68
    v_bfi_b32 v69, v19, s33, v69
    v_bfi_b32 v70, v19, s34, v70
    v_bfi_b32 v71, v19, s35, v71
    v_lshrrev_b32 v7, 5, v1
    v_lshlrev_b32 v7, 2, v7
    v_and_b32 v6, 3, v1
    v_add_u32 v7, v7, v6
    v_lshlrev_b32 v7, 4, v7
    s_mov_b32 exec_lo, 0xf
    s_mov_b32 exec_hi, 0xf
    global_store_dwordx4 v7, v[68:71], s[44:45] offset:1024 sc1
    s_mov_b64 exec, -1
    s_waitcnt lgkmcnt(0)
    s_mov_b64 exec, 1
    ds_add_u32 v2, v3 offset:48
    s_mov_b64 exec, -1
    s_mul_i32 s60, s38, 18432
    s_add_u32 s60, s60, 327680
    s_add_u32 s44, s26, s60
    s_addc_u32 s45, s27, 0
    v_lshrrev_b32 v5, 2, v1
    v_mul_u32_u24 v5, 1152, v5
    s_lshl_b32 s60, s40, 6
    s_add_u32 s60, s60, 1024
    v_add_u32 v7, s60, v5
    v_and_b32 v6, 3, v1
    v_lshl_add_u32 v5, v6, 4, v5
    s_lshl_b32 s60, s39, 6
    v_add_u32 v5, s60, v5
    s_cmp_eq_u32 s31, 0
    s_cbranch_scc1 L_gate_65
L_spin_66:
    ds_read_b32 v8, v2 offset:52
    s_waitcnt lgkmcnt(0)
    v_readfirstlane_b32 s60, v8
    s_nop 0
    s_cmp_ge_u32 s60, 5
    s_cbranch_scc1 L_spind_67
    s_sub_u32 s42, s42, 1
    s_cbranch_scc1 L_spind_67
    s_sleep 1
    s_branch L_spin_66
L_spind_67:
L_gate_65:
    s_mov_b32 s62, -1
    s_mov_b32 s63, -1
    s_mov_b64 exec, s[62:63]
    global_load_dwordx4 v[96:99], v5, s[44:45] sc1
    global_load_dwordx4 v[100:103], v7, s[44:45] sc1
    global_load_dwordx4 v[104:107], v5, s[44:45] sc1
    global_load_dwordx4 v[108:111], v7, s[44:45] sc1
    s_mov_b64 exec, -1
L_pp_68:
    s_waitcnt vmcnt(2)
    v_xor_b32 v9, s32, v96
    v_xor_b32 v10, s33, v97
    v_or_b32 v8, v9, v10
    v_xor_b32 v9, s34, v98
    v_xor_b32 v10, s35, v99
    v_or3_b32 v8, v8, v9, v10
    v_xor_b32 v9, s32, v100
    v_xor_b32 v10, s33, v101
    v_or3_b32 v8, v8, v9, v10
    v_xor_b32 v9, s34, v102
    v_xor_b32 v10, s35, v103
    v_or3_b32 v8, v8, v9, v10
    v_and_b32 v8, v19, v8
    v_cmp_ne_u32 vcc, 0, v8
    s_nop 0
    s_andn2_b64 s[66:67], s[62:63], vcc
    s_cbranch_scc0 L_pps_70
    s_mov_b64 exec, s[66:67]
    v_mov_b32 v64, v96
    v_mov_b32 v65, v97
    v_mov_b32 v66, v98
    v_mov_b32 v67, v99
    v_mov_b32 v68, v100
    v_mov_b32 v69, v101
    v_mov_b32 v70, v102
    v_mov_b32 v71, v103
    s_and_b64 s[62:63], s[62:63], vcc
    s_mov_b64 exec, -1
    s_cbranch_scc0 L_ppd_69
L_pps_70:
    s_mov_b64 exec, s[62:63]
    global_load_dwordx4 v[96:99], v5, s[44:45] sc1
    global_load_dwordx4 v[100:103], v7, s[44:45] sc1
    s_mov_b64 exec, -1
    s_waitcnt vmcnt(2)
    v_xor_b32 v9, s32, v104
    v_xor_b32 v10, s33, v105
    v_or_b32 v8, v9, v10
    v_xor_b32 v9, s34, v106
    v_xor_b32 v10, s35, v107
    v_or3_b32 v8, v8, v9, v10
    v_xor_b32 v9, s32, v108
    v_xor_b32 v10, s33, v109
    v_or3_b32 v8, v8, v9, v10
    v_xor_b32 v9, s34, v110
    v_xor_b32 v10, s35, v111
    v_or3_b32 v8, v8, v9, v10
    v_and_b32 v8, v19, v8
    v_cmp_ne_u32 vcc, 0, v8
    s_nop 0
    s_andn2_b64 s[66:67], s[62:63], vcc
    s_cbranch_scc0 L_pps_71
    s_mov_b64 exec, s[66:67]
    v_mov_b32 v64, v104
    v_mov_b32 v65, v105
    v_mov_b32 v66, v106
    v_mov_b32 v67, v107
    v_mov_b32 v68, v108
    v_mov_b32 v69, v109
    v_mov_b32 v70, v110
    v_mov_b32 v71, v111
    s_and_b64 s[62:63], s[62:63], vcc
    s_mov_b64 exec, -1
    s_cbranch_scc0 L_ppd_69
L_pps_71:
    s_mov_b64 exec, s[62:63]
    global_load_dwordx4 v[104:107], v5, s[44:45] sc1
    global_load_dwordx4 v[108:111], v7, s[44:45] sc1
    s_mov_b64 exec, -1
    s_sub_u32 s42, s42, 64
    s_cbranch_scc0 L_pp_68
L_ppd_69:
    s_mov_b64 exec, -1
    v_and_b32 v64, 0xfffff000, v64
    v_and_b32 v65, 0xfffff000, v65
    v_and_b32 v66, 0xfffff000, v66
    v_and_b32 v67, 0xfffff000, v67
    v_and_b32 v68, 0xfffff000, v68
    v_and_b32 v69, 0xfffff000, v69
    v_mov_b32 v8, v68
    s_nop 1
    v_max_f32_dpp v8, v8, v8 row_ror:4 row_mask:0xf bank_mask:0xf
    s_nop 1
    v_max_f32_dpp v8, v8, v8 row_ror:8 row_mask:0xf bank_mask:0xf
    v_mov_b32 v9, v8
    s_nop 1
    v_permlane16_swap_b32 v8, v9
    v_max_f32 v8, v8, v9
    v_sub_f32 v8, v68, v8
    v_mul_f32 v8, 0x3fb8aa3b, v8
    v_exp_f32 v8, v8
    s_nop 0
    v_mul_f32 v69, v8, v69
    v_mul_f32 v64, v8, v64
    v_mul_f32 v65, v8, v65
    v_mul_f32 v66, v8, v66
    v_mul_f32 v67, v8, v67
    v_add_f32_dpp v64, v64, v64 row_ror:4 row_mask:0xf bank_mask:0xf
    v_add_f32_dpp v65, v65, v65 row_ror:4 row_mask:0xf bank_mask:0xf
    v_add_f32_dpp v66, v66, v66 row_ror:4 row_mask:0xf bank_mask:0xf
    v_add_f32_dpp v67, v67, v67 row_ror:4 row_mask:0xf bank_mask:0xf
    v_add_f32_dpp v69, v69, v69 row_ror:4 row_mask:0xf bank_mask:0xf
    v_add_f32_dpp v64, v64, v64 row_ror:8 row_mask:0xf bank_mask:0xf
    v_add_f32_dpp v65, v65, v65 row_ror:8 row_mask:0xf bank_mask:0xf
    v_add_f32_dpp v66, v66, v66 row_ror:8 row_mask:0xf bank_mask:0xf
    v_add_f32_dpp v67, v67, v67 row_ror:8 row_mask:0xf bank_mask:0xf
    v_add_f32_dpp v69, v69, v69 row_ror:8 row_mask:0xf bank_mask:0xf
    v_mov_b32 v8, v64
    v_mov_b32 v9, v65
    v_mov_b32 v10, v66
    v_mov_b32 v11, v67
    v_mov_b32 v12, v69
    v_permlane16_swap_b32 v64, v8
    v_permlane16_swap_b32 v65, v9
    v_permlane16_swap_b32 v66, v10
    v_permlane16_swap_b32 v67, v11
    v_permlane16_swap_b32 v69, v12
    v_add_f32 v64, v64, v8
    v_add_f32 v65, v65, v9
    v_add_f32 v66, v66, v10
    v_add_f32 v67, v67, v11
    v_add_f32 v69, v69, v12
    v_rcp_f32 v8, v69
    s_nop 0
    v_fma_f32 v9, -v69, v8, 1.0
    v_fma_f32 v8, v8, v9, v8
    v_mul_f32 v64, v64, v8
    v_mul_f32 v65, v65, v8
    v_mul_f32 v66, v66, v8
    v_mul_f32 v67, v67, v8
    v_cvt_pk_bf16_f32 v8, v64, v65
    v_cvt_pk_bf16_f32 v9, v66, v67
    v_lshrrev_b32 v10, 5, v1
    v_lshlrev_b32 v10, 2, v10
    v_and_b32 v11, 3, v1
    v_add_u32 v10, v10, v11
    v_lshlrev_b32 v10, 3, v10
    s_mov_b32 exec_lo, 0xf
    s_mov_b32 exec_hi, 0xf
    ds_write_b64 v10, v[8:9] offset:5632
    s_mov_b64 exec, -1
    s_waitcnt lgkmcnt(0)
    s_mov_b64 exec, 1
    ds_add_u32 v2, v3 offset:28
    s_mov_b64 exec, -1
L_vrole:
    s_cmp_eq_u32 s31, 0
    s_cbranch_scc1 L_vwd
    s_cmp_lg_u32 s31, 1
    s_cbranch_scc1 L_vfinal
    s_mul_i32 s60, s2, 18
    s_and_b32 s64, s60, 3
    s_lshr_b32 s60, s60, 2
    s_lshl_b32 s60, s60, 4
    s_add_u32 s60, s60, 655360
    s_add_u32 s44, s26, s60
    s_addc_u32 s45, s27, 0
    v_lshrrev_b32 v5, 2, v1
    v_mul_u32_u24 v5, 18432, v5
    v_and_b32 v6, 3, v1
    v_lshl_add_u32 v5, v6, 4, v5
    v_mov_b32 v64, 0
    v_mov_b32 v65, 0
    v_mov_b32 v66, 0
    v_mov_b32 v67, 0
    v_mov_b32 v68, 0
    v_mov_b32 v69, 0
    v_mov_b32 v70, 0
    v_mov_b32 v71, 0
L_gpoll_72:
    s_mov_b32 exec_hi, 0x0000ffff
    global_load_dwordx4 v[64:67], v5, s[44:45] sc1
    s_mov_b32 exec_lo, 0x11111111
    s_mov_b32 exec_hi, 0x00001111
    global_load_dwordx4 v[68:71], v5, s[44:45] offset:64 sc1
    s_waitcnt vmcnt(0)
    v_xor_b32 v8, s32, v68
    v_xor_b32 v9, s33, v69
    v_xor_b32 v10, s34, v70
    v_or3_b32 v8, v8, v9, v10
    v_xor_b32 v9, s35, v71
    v_or_b32 v8, v8, v9
    v_and_b32 v8, v19, v8
    v_cmp_ne_u32 vcc, 0, v8
    s_nop 0
    s_mov_b64 s[62:63], vcc
    s_mov_b32 exec_lo, -1
    s_mov_b32 exec_hi, 0x0000ffff
    v_xor_b32 v8, s32, v64
    v_xor_b32 v9, s33, v65
    v_xor_b32 v10, s34, v66
    v_or3_b32 v8, v8, v9, v10
    v_xor_b32 v9, s35, v67
    v_or_b32 v8, v8, v9
    v_and_b32 v8, v19, v8
    v_cmp_ne_u32 vcc, 0, v8
    s_nop 0
    s_or_b64 vcc, vcc, s[62:63]
    s_mov_b64 exec, -1
    s_cbranch_vccz L_gdone_73
    s_sleep 8
    s_sub_u32 s42, s42, 64
    s_cbranch_scc0 L_gpoll_72
L_gdone_73:
    v_and_b32 v64, 0xfffff000, v64
    v_and_b32 v65, 0xfffff000, v65
    v_and_b32 v66, 0xfffff000, v66
    v_and_b32 v67, 0xfffff000, v67
    v_and_b32 v68, 0xfffff000, v68
    v_and_b32 v69, 0xfffff000, v69
    v_and_b32 v70, 0xfffff000, v70
    v_and_b32 v71, 0xfffff000, v71
    v_mov_b32 v72, v64
    v_mov_b32 v73, v65
    v_mov_b32 v74, v66
    v_mov_b32 v75, v67
    v_mov_b32 v76, v68
    v_mov_b32 v77, v69
    v_mov_b32 v78, v70
    v_mov_b32 v79, v71
    v_permlane16_swap_b32 v64, v72
    v_permlane16_swap_b32 v65, v73
    v_permlane16_swap_b32 v66, v74
    v_permlane16_swap_b32 v67, v75
    v_permlane16_swap_b32 v68, v76
    v_permlane16_swap_b32 v69, v77
    v_permlane16_swap_b32 v70, v78
    v_permlane16_swap_b32 v71, v79
    v_add_f32 v64, v64, v72
    v_add_f32 v65, v65, v73
    v_add_f32 v66, v66, v74
    v_add_f32 v67, v67, v75
    v_add_f32 v68, v68, v76
    v_add_f32 v69, v69, v77
    v_add_f32 v70, v70, v78
    v_add_f32 v71, v71, v79
    v_mov_b32 v72, v64
    v_mov_b32 v73, v65
    v_mov_b32 v74, v66
    v_mov_b32 v75, v67
    v_mov_b32 v76, v68
    v_mov_b32 v77, v69
    v_mov_b32 v78, v70
    v_mov_b32 v79, v71
    v_permlane32_swap_b32 v64, v72
    v_permlane32_swap_b32 v65, v73
    v_permlane32_swap_b32 v66, v74
    v_permlane32_swap_b32 v67, v75
    v_permlane32_swap_b32 v68, v76
    v_permlane32_swap_b32 v69, v77
    v_permlane32_swap_b32 v70, v78
    v_permlane32_swap_b32 v71, v79
    v_add_f32 v64, v64, v72
    v_add_f32 v65, v65, v73
    v_add_f32 v66, v66, v74
    v_add_f32 v67, v67, v75
    v_add_f32 v68, v68, v76
    v_add_f32 v69, v69, v77
    v_add_f32 v70, v70, v78
    v_add_f32 v71, v71, v79
    v_cvt_pk_bf16_f32 v72, v64, v65
    v_cvt_pk_bf16_f32 v73, v66, v67
    v_cvt_pk_bf16_f32 v74, v68, v69
    v_cvt_pk_bf16_f32 v75, v70, v71
    v_lshlrev_b32 v64, 16, v72
    v_and_b32 v65, 0xffff0000, v72
    v_lshlrev_b32 v66, 16, v73
    v_and_b32 v67, 0xffff0000, v73
    v_lshlrev_b32 v68, 16, v74
    v_and_b32 v69, 0xffff0000, v74
    v_lshlrev_b32 v70, 16, v75
    v_and_b32 v71, 0xffff0000, v75
    v_mul_f32_dpp v72, v64, v64 row_ror:8 row_mask:0xf bank_mask:0xf
    v_mul_f32_dpp v73, v65, v65 row_ror:8 row_mask:0xf bank_mask:0xf
    v_mul_f32_dpp v74, v66, v66 row_ror:8 row_mask:0xf bank_mask:0xf
    v_mul_f32_dpp v75, v67, v67 row_ror:8 row_mask:0xf bank_mask:0xf
    v_mul_f32_dpp v76, v68, v68 row_ror:8 row_mask:0xf bank_mask:0xf
    v_mul_f32_dpp v77, v69, v69 row_ror:8 row_mask:0xf bank_mask:0xf
    v_mul_f32_dpp v78, v70, v70 row_ror:8 row_mask:0xf bank_mask:0xf
    v_mul_f32_dpp v79, v71, v71 row_ror:8 row_mask:0xf bank_mask:0xf
    v_cvt_pk_bf16_f32 v64, v72, v73
    v_cvt_pk_bf16_f32 v65, v74, v75
    v_cvt_pk_bf16_f32 v66, v76, v77
    v_cvt_pk_bf16_f32 v67, v78, v79
    v_bfe_u32 v8, v1, 2, 1
    v_lshlrev_b32 v8, 6, v8
    v_lshlrev_b32 v9, 2, v6
    v_subrev_u32 v9, s64, v9
    s_mov_b64 exec, 0xff
    v_add_u32 v10, 0, v9
    v_and_b32 v11, 3, v10
    v_lshlrev_b32 v11, 4, v11
    v_lshrrev_b32 v12, 2, v10
    v_lshl_add_u32 v11, v12, 1, v11
    v_add_u32 v11, v11, v8
    v_cmp_gt_u32 vcc, 18, v10
    v_mov_b32 v12, 128
    s_nop 0
    v_cndmask_b32 v11, v12, v11, vcc
    ds_write_b16 v11, v64 offset:5696
    v_add_u32 v10, 1, v9
    v_and_b32 v11, 3, v10
    v_lshlrev_b32 v11, 4, v11
    v_lshrrev_b32 v12, 2, v10
    v_lshl_add_u32 v11, v12, 1, v11
    v_add_u32 v11, v11, v8
    v_cmp_gt_u32 vcc, 18, v10
    v_mov_b32 v12, 128
    s_nop 0
    v_cndmask_b32 v11, v12, v11, vcc
    ds_write_b16_d16_hi v11, v64 offset:5696
    v_add_u32 v10, 2, v9
    v_and_b32 v11, 3, v10
    v_lshlrev_b32 v11, 4, v11
    v_lshrrev_b32 v12, 2, v10
    v_lshl_add_u32 v11, v12, 1, v11
    v_add_u32 v11, v11, v8
    v_cmp_gt_u32 vcc, 18, v10
    v_mov_b32 v12, 128
    s_nop 0
    v_cndmask_b32 v11, v12, v11, vcc
    ds_write_b16 v11, v65 offset:5696
    v_add_u32 v10, 3, v9
    v_and_b32 v11, 3, v10
    v_lshlrev_b32 v11, 4, v11
    v_lshrrev_b32 v12, 2, v10
    v_lshl_add_u32 v11, v12, 1, v11
    v_add_u32 v11, v11, v8
    v_cmp_gt_u32 vcc, 18, v10
    v_mov_b32 v12, 128
    s_nop 0
    v_cndmask_b32 v11, v12, v11, vcc
    ds_write_b16_d16_hi v11, v65 offset:5696
    v_add_u32 v10, 16, v9
    v_and_b32 v11, 3, v10
    v_lshlrev_b32 v11, 4, v11
    v_lshrrev_b32 v12, 2, v10
    v_lshl_add_u32 v11, v12, 1, v11
    v_add_u32 v11, v11, v8
    v_cmp_gt_u32 vcc, 18, v10
    s_nop 0
    s_and_b64 vcc, vcc, 0x11
    v_mov_b32 v12, 128
    v_cndmask_b32 v11, v12, v11, vcc
    ds_write_b16 v11, v66 offset:5696
    v_add_u32 v10, 17, v9
    v_and_b32 v11, 3, v10
    v_lshlrev_b32 v11, 4, v11
    v_lshrrev_b32 v12, 2, v10
    v_lshl_add_u32 v11, v12, 1, v11
    v_add_u32 v11, v11, v8
    v_cmp_gt_u32 vcc, 18, v10
    s_nop 0
    s_and_b64 vcc, vcc, 0x11
    v_mov_b32 v12, 128
    v_cndmask_b32 v11, v12, v11, vcc
    ds_write_b16_d16_hi v11, v66 offset:5696
    v_add_u32 v10, 18, v9
    v_and_b32 v11, 3, v10
    v_lshlrev_b32 v11, 4, v11
    v_lshrrev_b32 v12, 2, v10
    v_lshl_add_u32 v11, v12, 1, v11
    v_add_u32 v11, v11, v8
    v_cmp_gt_u32 vcc, 18, v10
    s_nop 0
    s_and_b64 vcc, vcc, 0x11
    v_mov_b32 v12, 128
    v_cndmask_b32 v11, v12, v11, vcc
    ds_write_b16 v11, v67 offset:5696
    v_add_u32 v10, 19, v9
    v_and_b32 v11, 3, v10
    v_lshlrev_b32 v11, 4, v11
    v_lshrrev_b32 v12, 2, v10
    v_lshl_add_u32 v11, v12, 1, v11
    v_add_u32 v11, v11, v8
    v_cmp_gt_u32 vcc, 18, v10
    s_nop 0
    s_and_b64 vcc, vcc, 0x11
    v_mov_b32 v12, 128
    v_cndmask_b32 v11, v12, v11, vcc
    ds_write_b16_d16_hi v11, v67 offset:5696
    s_mov_b64 exec, -1
    s_waitcnt lgkmcnt(0)
    s_mov_b64 exec, 1
    ds_add_u32 v2, v3 offset:32
    s_mov_b64 exec, -1
    s_branch L_vfinal
L_vwd:
    s_mov_b32 s43, 4
    s_waitcnt vmcnt(0)
    v_lshlrev_b32 v12, 4, v16
    s_lshl_b32 s66, s43, 8
    v_add_u32 v12, s66, v12
    v_mul_u32_u24 v13, 4608, v17
    v_add_u32 v13, v13, v12
    v_mul_u32_u24 v14, 1152, v17
    v_add_u32 v14, v14, v12
    s_lshl_b32 s66, s38, 8
    s_lshl_b32 s67, s39, 4
    s_add_u32 s66, s66, s67
    s_mul_i32 s66, s66, 1152
    s_add_u32 s48, s12, s66
    s_addc_u32 s49, s13, 0
    s_mul_i32 s66, s2, 20736
    s_add_u32 s50, s20, s66
    s_addc_u32 s51, s21, 0
    v_mov_b32 v120, 0
    v_mov_b32 v121, 0
    v_mov_b32 v122, 0
    v_mov_b32 v123, 0
L_spin_74:
    ds_read_b32 v15, v2 offset:44
    s_waitcnt lgkmcnt(0)
    v_readfirstlane_b32 s60, v15
    s_nop 0
    s_cmp_ge_u32 s60, 4
    s_cbranch_scc1 L_spind_75
    s_sub_u32 s42, s42, 1
    s_cbranch_scc1 L_spind_75
    s_sleep 1
    s_branch L_spin_74
L_spind_75:
    s_setprio 0
    s_mov_b32 exec_lo, 0x00ff00ff
    s_mov_b32 exec_hi, 0x00ff00ff
    global_load_dwordx4 v[88:91], v13, s[48:49] offset:0 nt
    global_load_dwordx4 v[92:95], v13, s[48:49] offset:1152 nt
    global_load_dwordx4 v[96:99], v13, s[48:49] offset:2304 nt
    global_load_dwordx4 v[100:103], v13, s[48:49] offset:3456 nt
    global_load_dwordx4 v[104:107], v14, s[50:51] nt
    v_add_u32 v14, 4608, v14
    global_load_dwordx4 v[108:111], v14, s[50:51] nt
    v_add_u32 v14, 4608, v14
    global_load_dwordx4 v[112:115], v14, s[50:51] nt
    v_add_u32 v14, 4608, v14
    global_load_dwordx4 v[116:119], v14, s[50:51] nt
    v_add_u32 v14, 4608, v14
    s_mov_b32 exec_hi, 0
    global_load_dwordx4 v[120:123], v14, s[50:51] nt
    s_mov_b64 exec, -1
    s_mov_b64 exec, 1
    ds_add_u32 v2, v3 offset:52
    s_mov_b64 exec, -1
    s_setprio 3
    s_waitcnt vmcnt(0)
    v_perm_b32 v32, v92, v88, s36
    v_perm_b32 v33, v100, v96, s36
    v_perm_b32 v34, v92, v88, s37
    v_perm_b32 v35, v100, v96, s37
    v_perm_b32 v36, v93, v89, s36
    v_perm_b32 v37, v101, v97, s36
    v_perm_b32 v38, v93, v89, s37
    v_perm_b32 v39, v101, v97, s37
    v_perm_b32 v40, v94, v90, s36
    v_perm_b32 v41, v102, v98, s36
    v_perm_b32 v42, v94, v90, s37
    v_perm_b32 v43, v102, v98, s37
    v_perm_b32 v44, v95, v91, s36
    v_perm_b32 v45, v103, v99, s36
    v_perm_b32 v46, v95, v91, s37
    v_perm_b32 v47, v103, v99, s37
    v_perm_b32 v48, v108, v104, s36
    v_perm_b32 v49, v116, v112, s36
    v_and_b32 v50, 0xffff, v120
    v_mov_b32 v51, 0
    v_perm_b32 v52, v108, v104, s37
    v_perm_b32 v53, v116, v112, s37
    v_lshrrev_b32 v54, 16, v120
    v_mov_b32 v55, 0
    v_perm_b32 v56, v109, v105, s36
    v_perm_b32 v57, v117, v113, s36
    v_and_b32 v58, 0xffff, v121
    v_mov_b32 v59, 0
    v_perm_b32 v60, v109, v105, s37
    v_perm_b32 v61, v117, v113, s37
    v_lshrrev_b32 v62, 16, v121
    v_mov_b32 v63, 0
    v_perm_b32 v64, v110, v106, s36
    v_perm_b32 v65, v118, v114, s36
    v_and_b32 v66, 0xffff, v122
    v_mov_b32 v67, 0
    v_perm_b32 v68, v110, v106, s37
    v_perm_b32 v69, v118, v114, s37
    v_lshrrev_b32 v70, 16, v122
    v_mov_b32 v71, 0
    v_perm_b32 v72, v111, v107, s36
    v_perm_b32 v73, v119, v115, s36
    v_and_b32 v74, 0xffff, v123
    v_mov_b32 v75, 0
    v_perm_b32 v76, v111, v107, s37
    v_perm_b32 v77, v119, v115, s37
    v_lshrrev_b32 v78, 16, v123
    v_mov_b32 v79, 0
    v_and_b32 v4, 1, v1
    v_lshlrev_b32 v4, 2, v4
    v_add_u32 v4, v4, v17
    v_lshlrev_b32 v5, 3, v4
    v_lshlrev_b32 v6, 4, v4
    v_lshrrev_b32 v7, 2, v16
    v_lshl_add_u32 v7, v17, 1, v7
    v_add_u32 v7, 64, v7
    v_lshlrev_b32 v7, 14, v7
    v_and_b32 v8, 3, v16
    v_lshl_add_u32 v7, v8, 4, v7
    s_lshl_b32 s60, s2, 6
    s_add_u32 s60, s60, 1048576
    s_add_u32 s44, s26, s60
    s_addc_u32 s45, s27, 0
L_spin_76:
    ds_read_b32 v15, v2 offset:32
    s_waitcnt lgkmcnt(0)
    v_readfirstlane_b32 s60, v15
    s_nop 0
    s_cmp_ge_u32 s60, 1
    s_cbranch_scc1 L_spind_77
    s_sub_u32 s42, s42, 1
    s_cbranch_scc1 L_spind_77
    s_branch L_spin_76
L_spind_77:
    ds_read_b128 v[12:15], v6 offset:5696
    s_waitcnt lgkmcnt(0)
    v_mfma_f32_16x16x32_bf16 v[80:83], v[12:15], v[48:51], 0
    v_mfma_f32_16x16x32_bf16 v[84:87], v[12:15], v[52:55], 0
    v_mfma_f32_16x16x32_bf16 v[88:91], v[12:15], v[56:59], 0
    v_mfma_f32_16x16x32_bf16 v[92:95], v[12:15], v[60:63], 0
    v_mfma_f32_16x16x32_bf16 v[96:99], v[12:15], v[64:67], 0
    v_mfma_f32_16x16x32_bf16 v[100:103], v[12:15], v[68:71], 0
    v_mfma_f32_16x16x32_bf16 v[104:107], v[12:15], v[72:75], 0
    v_mfma_f32_16x16x32_bf16 v[108:111], v[12:15], v[76:79], 0
L_spin_78:
    ds_read_b32 v10, v2 offset:28
    s_waitcnt lgkmcnt(0)
    v_readfirstlane_b32 s60, v10
    s_nop 0
    s_cmp_ge_u32 s60, 1
    s_cbranch_scc1 L_spind_79
    s_sub_u32 s42, s42, 1
    s_cbranch_scc1 L_spind_79
    s_branch L_spin_78
L_spind_79:
    ds_read_b64 v[8:9], v5 offset:5632
    s_waitcnt lgkmcnt(0)
    v_mfma_f32_16x16x16_bf16 v[80:83], v[8:9], v[32:33], v[80:83]
    v_mfma_f32_16x16x16_bf16 v[84:87], v[8:9], v[34:35], v[84:87]
    v_mfma_f32_16x16x16_bf16 v[88:91], v[8:9], v[36:37], v[88:91]
    v_mfma_f32_16x16x16_bf16 v[92:95], v[8:9], v[38:39], v[92:95]
    v_mfma_f32_16x16x16_bf16 v[96:99], v[8:9], v[40:41], v[96:99]
    v_mfma_f32_16x16x16_bf16 v[100:103], v[8:9], v[42:43], v[100:103]
    v_mfma_f32_16x16x16_bf16 v[104:107], v[8:9], v[44:45], v[104:107]
    v_mfma_f32_16x16x16_bf16 v[108:111], v[8:9], v[46:47], v[108:111]
    s_mov_b32 s60, 0xffff0000
    s_mov_b32 s61, 0xffff0000
    s_mov_b32 s62, 0
    s_mov_b32 s63, -1
    v_cndmask_b32 v32, v80, v81, s[60:61]
    v_cndmask_b32 v33, v84, v85, s[60:61]
    v_cndmask_b32 v34, v88, v89, s[60:61]
    v_cndmask_b32 v35, v92, v93, s[60:61]
    v_cndmask_b32 v36, v96, v97, s[60:61]
    v_cndmask_b32 v37, v100, v101, s[60:61]
    v_cndmask_b32 v38, v104, v105, s[60:61]
    v_cndmask_b32 v39, v108, v109, s[60:61]
    v_cndmask_b32 v32, v32, v36, s[62:63]
    v_cndmask_b32 v33, v33, v37, s[62:63]
    v_cndmask_b32 v34, v34, v38, s[62:63]
    v_cndmask_b32 v35, v35, v39, s[62:63]
    v_bfi_b32 v32, v19, s32, v32
    v_bfi_b32 v33, v19, s33, v33
    v_bfi_b32 v34, v19, s34, v34
    v_bfi_b32 v35, v19, s35, v35
    s_mov_b32 exec_lo, 0x00ff00ff
    s_mov_b32 exec_hi, 0x00ff00ff
    global_store_dwordx4 v7, v[32:35], s[44:45] sc1
    s_mov_b64 exec, -1
    s_waitcnt lgkmcnt(0)
    s_mov_b64 exec, 1
    ds_add_u32 v2, v3 offset:36
    s_mov_b64 exec, -1
L_vfinal:
    s_cmp_ge_u32 s2, 72
    s_cbranch_scc1 L_vend
    s_lshr_b32 s64, s2, 4
    s_bfe_u32 s65, s2, 0x20002
    s_and_b32 s66, s2, 3
    s_bfe_u32 s67, s2, 0x20001
    s_and_b32 s68, s2, 1
    s_cmp_ge_u32 s2, 64
    s_cselect_b32 s64, 4, s64
    s_cselect_b32 s65, s67, s65
    s_cselect_b32 s66, s68, s66
    s_lshl_b32 s60, s2, 14
    s_lshl_b32 s61, s31, 11
    s_add_u32 s60, s60, s61
    s_add_u32 s60, s60, 1048576
    s_add_u32 s44, s26, s60
    s_addc_u32 s45, s27, 0
    v_lshlrev_b32 v5, 4, v1
    s_and_b32 s60, s65, 1
    s_mul_i32 s60, s60, 1152
    s_lshl_b32 s61, s64, 8
    s_add_u32 s60, s60, s61
    s_lshl_b32 s61, s66, 6
    s_add_u32 s60, s60, s61
    s_lshr_b32 s61, s65, 1
    s_lshl_b32 s61, s61, 3
    s_add_u32 s64, s60, s61
    v_and_b32 v6, 3, v1
    v_lshlrev_b32 v7, 4, v6
    v_add_u32 v6, s64, v7
    global_load_dwordx2 v[30:31], v6, s[4:5]
L_spin_80:
    ds_read_b32 v4, v2 offset:36
    s_waitcnt lgkmcnt(0)
    v_readfirstlane_b32 s60, v4
    s_nop 0
    s_cmp_ge_u32 s60, 5
    s_cbranch_scc1 L_spind_81
    s_sub_u32 s42, s42, 1
    s_cbranch_scc1 L_spind_81
    s_sleep 1
    s_branch L_spin_80
L_spind_81:
    s_mov_b32 s62, -1
    s_mov_b32 s63, -1
    s_mov_b64 exec, s[62:63]
    global_load_dwordx4 v[96:99], v5, s[44:45] sc1
    global_load_dwordx4 v[100:103], v5, s[44:45] offset:1024 sc1
    global_load_dwordx4 v[104:107], v5, s[44:45] sc1
    global_load_dwordx4 v[108:111], v5, s[44:45] offset:1024 sc1
    s_mov_b64 exec, -1
L_pp_82:
    s_waitcnt vmcnt(2)
    v_xor_b32 v9, s32, v96
    v_xor_b32 v10, s33, v97
    v_or_b32 v8, v9, v10
    v_xor_b32 v9, s34, v98
    v_xor_b32 v10, s35, v99
    v_or3_b32 v8, v8, v9, v10
    v_xor_b32 v9, s32, v100
    v_xor_b32 v10, s33, v101
    v_or3_b32 v8, v8, v9, v10
    v_xor_b32 v9, s34, v102
    v_xor_b32 v10, s35, v103
    v_or3_b32 v8, v8, v9, v10
    v_and_b32 v8, v19, v8
    v_cmp_ne_u32 vcc, 0, v8
    s_nop 0
    s_andn2_b64 s[66:67], s[62:63], vcc
    s_cbranch_scc0 L_pps_84
    s_mov_b64 exec, s[66:67]
    v_mov_b32 v64, v96
    v_mov_b32 v65, v97
    v_mov_b32 v66, v98
    v_mov_b32 v67, v99
    v_mov_b32 v68, v100
    v_mov_b32 v69, v101
    v_mov_b32 v70, v102
    v_mov_b32 v71, v103
    s_and_b64 s[62:63], s[62:63], vcc
    s_mov_b64 exec, -1
    s_cbranch_scc0 L_ppd_83
L_pps_84:
    s_mov_b64 exec, s[62:63]
    global_load_dwordx4 v[96:99], v5, s[44:45] sc1
    global_load_dwordx4 v[100:103], v5, s[44:45] offset:1024 sc1
    s_mov_b64 exec, -1
    s_waitcnt vmcnt(2)
    v_xor_b32 v9, s32, v104
    v_xor_b32 v10, s33, v105
    v_or_b32 v8, v9, v10
    v_xor_b32 v9, s34, v106
    v_xor_b32 v10, s35, v107
    v_or3_b32 v8, v8, v9, v10
    v_xor_b32 v9, s32, v108
    v_xor_b32 v10, s33, v109
    v_or3_b32 v8, v8, v9, v10
    v_xor_b32 v9, s34, v110
    v_xor_b32 v10, s35, v111
    v_or3_b32 v8, v8, v9, v10
    v_and_b32 v8, v19, v8
    v_cmp_ne_u32 vcc, 0, v8
    s_nop 0
    s_andn2_b64 s[66:67], s[62:63], vcc
    s_cbranch_scc0 L_pps_85
    s_mov_b64 exec, s[66:67]
    v_mov_b32 v64, v104
    v_mov_b32 v65, v105
    v_mov_b32 v66, v106
    v_mov_b32 v67, v107
    v_mov_b32 v68, v108
    v_mov_b32 v69, v109
    v_mov_b32 v70, v110
    v_mov_b32 v71, v111
    s_and_b64 s[62:63], s[62:63], vcc
    s_mov_b64 exec, -1
    s_cbranch_scc0 L_ppd_83
L_pps_85:
    s_mov_b64 exec, s[62:63]
    global_load_dwordx4 v[104:107], v5, s[44:45] sc1
    global_load_dwordx4 v[108:111], v5, s[44:45] offset:1024 sc1
    s_mov_b64 exec, -1
    s_sub_u32 s42, s42, 64
    s_cbranch_scc0 L_pp_82
L_ppd_83:
    s_mov_b64 exec, -1
    v_and_b32 v64, 0xfffff000, v64
    v_and_b32 v65, 0xfffff000, v65
    v_and_b32 v66, 0xfffff000, v66
    v_and_b32 v67, 0xfffff000, v67
    v_and_b32 v68, 0xfffff000, v68
    v_and_b32 v69, 0xfffff000, v69
    v_and_b32 v70, 0xfffff000, v70
    v_and_b32 v71, 0xfffff000, v71
    v_add_f32 v64, v64, v68
    v_add_f32 v65, v65, v69
    v_add_f32 v66, v66, v70
    v_add_f32 v67, v67, v71
    v_add_f32_dpp v64, v64, v64 row_ror:4 row_mask:0xf bank_mask:0xf
    v_add_f32_dpp v65, v65, v65 row_ror:4 row_mask:0xf bank_mask:0xf
    v_add_f32_dpp v66, v66, v66 row_ror:4 row_mask:0xf bank_mask:0xf
    v_add_f32_dpp v67, v67, v67 row_ror:4 row_mask:0xf bank_mask:0xf
    v_add_f32_dpp v64, v64, v64 row_ror:8 row_mask:0xf bank_mask:0xf
    v_add_f32_dpp v65, v65, v65 row_ror:8 row_mask:0xf bank_mask:0xf
    v_add_f32_dpp v66, v66, v66 row_ror:8 row_mask:0xf bank_mask:0xf
    v_add_f32_dpp v67, v67, v67 row_ror:8 row_mask:0xf bank_mask:0xf
    v_mov_b32 v8, v64
    v_mov_b32 v9, v65
    v_mov_b32 v10, v66
    v_mov_b32 v11, v67
    v_permlane16_swap_b32 v64, v8
    v_permlane16_swap_b32 v65, v9
    v_permlane16_swap_b32 v66, v10
    v_permlane16_swap_b32 v67, v11
    v_add_f32 v64, v64, v8
    v_add_f32 v65, v65, v9
    v_add_f32 v66, v66, v10
    v_add_f32 v67, v67, v11
    v_mov_b32 v8, v64
    v_mov_b32 v9, v65
    v_mov_b32 v10, v66
    v_mov_b32 v11, v67
    v_permlane32_swap_b32 v64, v8
    v_permlane32_swap_b32 v65, v9
    v_permlane32_swap_b32 v66, v10
    v_permlane32_swap_b32 v67, v11
    v_add_f32 v64, v64, v8
    v_add_f32 v65, v65, v9
    v_add_f32 v66, v66, v10
    v_add_f32 v67, v67, v11
    s_lshl_b32 s60, s31, 6
    v_add_u32 v8, s60, v7
    s_mov_b64 exec, 15
    ds_write_b128 v8, v[64:67] offset:6144
    s_mov_b64 exec, -1
    s_waitcnt lgkmcnt(0)
    s_mov_b64 exec, 1
    ds_add_rtn_u32 v4, v2, v3 offset:40
    s_mov_b64 exec, -1
    s_waitcnt lgkmcnt(0)
    v_readfirstlane_b32 s60, v4
    s_nop 0
    s_cmp_lg_u32 s60, 7
    s_cbranch_scc1 L_vend
    ds_read_b128 v[64:67], v7 offset:6144
    ds_read_b128 v[68:71], v7 offset:6208
    ds_read_b128 v[72:75], v7 offset:6272
    ds_read_b128 v[76:79], v7 offset:6336
    ds_read_b128 v[80:83], v7 offset:6400
    ds_read_b128 v[84:87], v7 offset:6464
    ds_read_b128 v[88:91], v7 offset:6528
    ds_read_b128 v[92:95], v7 offset:6592
    s_waitcnt lgkmcnt(0)
    v_add_f32 v64, v64, v68
    v_add_f32 v65, v65, v69
    v_add_f32 v66, v66, v70
    v_add_f32 v67, v67, v71
    v_add_f32 v64, v64, v72
    v_add_f32 v65, v65, v73
    v_add_f32 v66, v66, v74
    v_add_f32 v67, v67, v75
    v_add_f32 v64, v64, v76
    v_add_f32 v65, v65, v77
    v_add_f32 v66, v66, v78
    v_add_f32 v67, v67, v79
    v_add_f32 v64, v64, v80
    v_add_f32 v65, v65, v81
    v_add_f32 v66, v66, v82
    v_add_f32 v67, v67, v83
    v_add_f32 v64, v64, v84
    v_add_f32 v65, v65, v85
    v_add_f32 v66, v66, v86
    v_add_f32 v67, v67, v87
    v_add_f32 v64, v64, v88
    v_add_f32 v65, v65, v89
    v_add_f32 v66, v66, v90
    v_add_f32 v67, v67, v91
    v_add_f32 v64, v64, v92
    v_add_f32 v65, v65, v93
    v_add_f32 v66, v66, v94
    v_add_f32 v67, v67, v95
    v_lshlrev_b32 v8, 16, v30
    v_and_b32 v9, 0xffff0000, v30
    v_lshlrev_b32 v10, 16, v31
    v_and_b32 v11, 0xffff0000, v31
    v_add_f32 v64, v64, v8
    v_add_f32 v65, v65, v9
    v_add_f32 v66, v66, v10
    v_add_f32 v67, v67, v11
    v_cvt_pk_bf16_f32 v8, v64, v65
    v_cvt_pk_bf16_f32 v9, v66, v67
    s_mov_b64 exec, 15
    global_store_dwordx2 v6, v[8:9], s[22:23]
    s_cmp_lg_u32 s2, 0
    s_cbranch_scc1 L_vend2
    s_mov_b64 exec, 1
    v_mov_b32 v8, s28
    global_store_dword v2, v8, s[26:27] sc1
L_vend2:
    s_mov_b64 exec, -1
L_vend:
L_end:
    s_endpgm
L_codeend:
    s_endpgm
.section .rodata,"a"
.p2align 6
.amdhsa_kernel parallel_sum__gqa_block_cached__glu_gated_bilinear__decode_kernel
  .amdhsa_next_free_vgpr 128
  .amdhsa_next_free_sgpr 102
  .amdhsa_accum_offset 128
  .amdhsa_group_segment_fixed_size 0
  .amdhsa_kernarg_size 96
  .amdhsa_user_sgpr_count 2
  .amdhsa_user_sgpr_kernarg_segment_ptr 1
  .amdhsa_system_sgpr_workgroup_id_x 1
.end_amdhsa_kernel
```
